```python
import torch

def _softmax(x, axis=-1):
    return torch.softmax(x, dim=axis)
def _gelu(x):
    return torch.nn.functional.gelu(x, approximate="tanh")
def _silu(x):
    return torch.nn.functional.silu(x)
def _sigmoid(x):
    return torch.sigmoid(x)
def _layernorm(x, axis=-1, eps=1e-5):
    m = x.mean(dim=axis, keepdim=True)
    v = x.var(dim=axis, keepdim=True, unbiased=False)
    return (x - m) / torch.sqrt(v + eps)
def _scatter_add(tgt, idx, src, axis=0):
    return tgt.clone().index_add_(axis, idx, src)
def _segment_sum(src, seg, n):
    out = torch.zeros((n,) + src.shape[1:], dtype=src.dtype)
    return out.index_add_(0, seg, src)
def _pad(x, pw):
    flat = tuple(v for pair in reversed(pw) for v in pair)
    return torch.nn.functional.pad(x, flat)

kernel_name = 'sequential_preLN__linear_attn_block__geglu_ffn__prompt'

def setup_inputs():

    _w = (lambda a: (lambda t: t.to(torch.bfloat16) if t.is_floating_point() else t)(torch.as_tensor(a)))
    def _A_setup():
        B, S, D = 1, 2048, 512
        return {
            "x": _w((lambda *s: torch.randn(*s, dtype=torch.bfloat16) * 0.05)(B, S, D)),
            "wqkv": _w((lambda *s: torch.randn(*s, dtype=torch.bfloat16) * 0.05)(D, 3 * D)),
            "wo": _w((lambda *s: torch.randn(*s, dtype=torch.bfloat16) * 0.05)(D, D)),
        }
    _A_in = _A_setup()

    def _B_setup():
        B, S, D, F = 1, 2048, 512, 1376
        return {
            "x": _w((lambda *s: torch.randn(*s, dtype=torch.bfloat16) * 0.05)(B, S, D)),
            "w_gate": _w((lambda *s: torch.randn(*s, dtype=torch.bfloat16) * 0.05)(D, F)),
            "w_up": _w((lambda *s: torch.randn(*s, dtype=torch.bfloat16) * 0.05)(D, F)),
            "w_down": _w((lambda *s: torch.randn(*s, dtype=torch.bfloat16) * 0.05)(F, D)),
        }
    _B_in = _B_setup()

    return {
        "A_x": _A_in["x"],
        "A_wqkv": _A_in["wqkv"],
        "A_wo": _A_in["wo"],
        "B_x": _B_in["x"],
        "B_w_gate": _B_in["w_gate"],
        "B_w_up": _B_in["w_up"],
        "B_w_down": _B_in["w_down"],
    }

def reference(A_x, A_wqkv, A_wo, B_x, B_w_gate, B_w_up, B_w_down):
    def _A_ref(x, wqkv, wo):
        B, S, D = x.shape
        H = 32; Dh = D // H
        qkv = (lambda x, *d: x.permute(*d))((x @ wqkv).reshape(B, S, 3, H, Dh), 2, 0, 3, 1, 4)
        q, k, v = qkv[0], qkv[1], qkv[2]
        phi = lambda t: torch.where(t > 0, t + 1, torch.exp(t)) + 1e-6
        pq, pk = phi(q), phi(k)
        kv = torch.einsum("bhsd,bhse->bhde", pk, v)
        z = torch.einsum("bhsd->bhd", pk)
        num = torch.einsum("bhqd,bhde->bhqe", pq, kv)
        den = torch.einsum("bhqd,bhd->bhq", pq, z)[..., None] + 1e-6
        o = num / den
        return (lambda x, *d: x.permute(*d))(o, 0, 2, 1, 3).reshape(B, S, D) @ wo

    def _B_ref(x, w_gate, w_up, w_down):
        return (_gelu(x @ w_gate) * (x @ w_up)) @ w_down

    x = A_x
    h = x + _A_ref(_layernorm(x, axis=-1), A_wqkv, A_wo)
    h2 = h + _B_ref(_layernorm(h, axis=-1), B_w_gate, B_w_up, B_w_down)
    return h2
```

```asm
; @launch grid=(256,1,1) block=(256,1,1) lds=163840
.amdgcn_target "amdgcn-amd-amdhsa--gfx950"
.text
.globl sequential_preLN__linear_attn_block__geglu_ffn__prompt_kernel
.p2align 8
.type sequential_preLN__linear_attn_block__geglu_ffn__prompt_kernel,@function
sequential_preLN__linear_attn_block__geglu_ffn__prompt_kernel:
    s_cmp_ge_u32 s2, 256
    s_cbranch_scc1 L_end
    s_load_dwordx16 s[4:19], s[0:1], 0
    s_load_dwordx4 s[20:23], s[0:1], 64
    s_getpc_b64 s[100:101]
L_pc:
    s_lshr_b32 s73, s2, 3
    s_lshl_b32 s73, s73, 10
    v_lshlrev_b32 v5, 7, v0
    v_add_u32 v4, s73, v5
    v_cmp_gt_u32 vcc, 8, v0
    v_subrev_u32 v5, 640, v5
    s_nop 0
    v_cndmask_b32 v5, v5, v4, vcc
    v_cmp_gt_u32 vcc, 24, v0
    v_min_u32 v5, L_end-L_pc, v5
    s_and_b64 exec, exec, vcc
    s_cbranch_execz L_npf_1
    global_load_dword v243, v5, s[100:101]
L_npf_1:
    s_mov_b64 exec, -1
    v_lshrrev_b32 v2, 6, v0
    v_and_b32 v1, 63, v0
    v_readfirstlane_b32 s60, v2
    s_and_b32 s61, s2, 7
    s_lshr_b32 s62, s2, 3
    s_and_b32 s72, s62, 7
    s_lshr_b32 s73, s62, 3
    s_lshr_b32 s74, s61, 1
    s_and_b32 s81, s61, 1
    s_lshl3_add_u32 s63, s74, s72
    s_lshl2_add_u32 s64, s81, s73
    s_lshl1_add_u32 s65, s73, s72
    v_lshrrev_b32 v2, 3, v1
    v_and_b32 v3, 7, v1
    v_and_b32 v4, 6, v2
    v_xor_b32 v4, v4, v3
    v_lshlrev_b32 v4, 4, v4
    v_lshl_add_u32 v6, v2, 10, v4
    v_add_u32 v7, 7168, v6
    s_and_b32 s75, s60, 1
    s_lshl_b32 s75, s75, 2
    v_and_b32 v4, 2, v2
    v_or_b32 v4, s75, v4
    v_xor_b32 v4, v4, v3
    v_lshlrev_b32 v4, 4, v4
    v_mul_u32_u24 v5, 3072, v2
    v_add_u32 v10, v5, v4
    v_add_u32 v8, 1024, v10
    v_add_u32 v9, 98304, v10
    v_add_u32 v11, 97280, v10
    s_lshl2_add_u32 s70, s63, s60
    s_lshl_b32 s70, s70, 14
    s_mul_i32 s71, s60, 24576
    s_lshl_b32 s75, s64, 7
    s_add_u32 s71, s71, s75
    s_lshl_b32 s76, s60, 11
    s_lshl_b32 s77, s60, 12
    s_add_u32 s77, s77, 65536
    s_mov_b32 s26, 2097152
    s_mov_b32 s27, 0x20000
    s_mov_b32 s30, 1572864
    s_mov_b32 s31, 0x20000
    s_waitcnt lgkmcnt(0)
    s_mov_b64 s[24:25], s[4:5]
    s_mov_b64 s[28:29], s[6:7]
    s_add_u32 m0, s76, 0
    s_add_u32 s72, s65, 0
    s_and_b32 s72, s72, 7
    s_lshl_b32 s73, s72, 7
    s_add_u32 s73, s73, s70
    buffer_load_dwordx4 v6, s[24:27], s73 offen lds
    buffer_load_dwordx4 v7, s[24:27], s73 offen offset:1024 lds
    s_add_u32 m0, s77, 0
    s_mul_i32 s73, s72, 196608
    s_add_u32 s73, s73, s71
    buffer_load_dwordx4 v8, s[28:31], s73 offen lds
    buffer_load_dwordx4 v9, s[28:31], s73 offen offset:1024 lds
    buffer_load_dwordx4 v10, s[28:31], s73 offen offset:2048 lds
    buffer_load_dwordx4 v11, s[28:31], s73 offen offset:3072 lds
    s_mov_b64 s[32:33], s[22:23]
    s_mov_b32 s34, 16777216
    s_mov_b32 s35, 0x20000
    s_cmp_ge_u32 s2, 16
    s_cbranch_scc1 L_sk_2
    v_mov_b32 v24, 0
    v_mov_b32 v25, 0
    v_mov_b32 v26, 0
    v_mov_b32 v27, 0
    v_lshlrev_b32 v5, 4, v0
    s_lshl_b32 s73, s2, 12
    buffer_store_dwordx4 v[24:27], v5, s[32:35], s73 offen sc1
L_sk_2:
    s_add_u32 m0, s76, 8192
    s_add_u32 s72, s65, 1
    s_and_b32 s72, s72, 7
    s_lshl_b32 s73, s72, 7
    s_add_u32 s73, s73, s70
    buffer_load_dwordx4 v6, s[24:27], s73 offen lds
    buffer_load_dwordx4 v7, s[24:27], s73 offen offset:1024 lds
    s_add_u32 m0, s77, 16384
    s_mul_i32 s73, s72, 196608
    s_add_u32 s73, s73, s71
    buffer_load_dwordx4 v8, s[28:31], s73 offen lds
    buffer_load_dwordx4 v9, s[28:31], s73 offen offset:1024 lds
    buffer_load_dwordx4 v10, s[28:31], s73 offen offset:2048 lds
    buffer_load_dwordx4 v11, s[28:31], s73 offen offset:3072 lds
    v_lshlrev_b32 v242, 7, v1
    v_lshlrev_b32 v21, 4, v1
    v_lshlrev_b32 v22, 2, v1
    v_mov_b32 v23, 1
    v_mov_b32 v24, 0x3f803f80
    v_mov_b32 v25, 0x3f803f80
    v_mov_b32 v26, 0x3f803f80
    v_mov_b32 v27, 0x3f803f80
    v_and_b32 v44, 15, v1
    v_lshrrev_b32 v45, 4, v1
    v_bfe_u32 v46, v1, 2, 2
    v_and_b32 v47, 1, v1
    v_bfe_u32 v48, v1, 1, 1
    v_lshrrev_b32 v49, 5, v1
    v_bfe_u32 v50, v1, 4, 1
    v_and_b32 v51, 31, v1
    v_lshrrev_b32 v52, 3, v1
    v_and_b32 v53, 7, v1
    v_bfe_u32 v3, v1, 3, 1
    v_lshlrev_b32 v3, 10, v3
    v_lshl_add_u32 v3, v53, 7, v3
    v_and_b32 v2, 6, v53
    v_xor_b32 v2, v2, v45
    v_lshl_add_u32 v3, v2, 4, v3
    v_add_u32 v3, s76, v3
    v_xor_b32 v12, 0, v3
    v_xor_b32 v16, 64, v3
    v_xor_b32 v13, 2048, v3
    v_xor_b32 v17, 2112, v3
    v_xor_b32 v14, 4096, v3
    v_xor_b32 v18, 4160, v3
    v_xor_b32 v15, 6144, v3
    v_xor_b32 v19, 6208, v3
    v_and_b32 v3, 2, v46
    v_lshl_or_b32 v3, v50, 2, v3
    s_lshl_b32 s72, s60, 1
    v_or_b32 v5, s72, v48
    v_xor_b32 v3, v3, v5
    v_lshlrev_b32 v3, 4, v3
    v_lshl_add_u32 v3, v46, 7, v3
    v_lshl_add_u32 v3, v45, 12, v3
    v_lshl_add_u32 v3, v47, 3, v3
    v_add_u32 v20, 65536, v3
    s_mov_b64 s[52:53], s[18:19]
    s_mov_b64 s[48:49], s[16:17]
    s_mov_b64 s[56:57], s[20:21]
    s_mov_b32 s58, 256
    s_mov_b32 s59, 0x20000
    s_add_u32 m0, s76, 16384
    s_add_u32 s72, s65, 2
    s_and_b32 s72, s72, 7
    s_lshl_b32 s73, s72, 7
    s_add_u32 s73, s73, s70
    buffer_load_dwordx4 v6, s[24:27], s73 offen lds
    buffer_load_dwordx4 v7, s[24:27], s73 offen offset:1024 lds
    s_add_u32 m0, s77, 32768
    s_add_u32 s72, s65, 2
    s_and_b32 s72, s72, 7
    s_mul_i32 s73, s72, 196608
    s_add_u32 s73, s73, s71
    buffer_load_dwordx4 v8, s[28:31], s73 offen lds
    buffer_load_dwordx4 v9, s[28:31], s73 offen offset:1024 lds
    buffer_load_dwordx4 v10, s[28:31], s73 offen offset:2048 lds
    buffer_load_dwordx4 v11, s[28:31], s73 offen offset:3072 lds
    s_waitcnt vmcnt(12)
    s_barrier
    ds_read_b64_tr_b16 v[60:61], v20 offset:0
    ds_read_b64_tr_b16 v[62:63], v20 offset:512
    ds_read_b128 a[0:3], v12 offset:0
    ds_read_b64_tr_b16 v[64:65], v20 offset:2048
    ds_read_b64_tr_b16 v[66:67], v20 offset:2560
    ds_read_b128 a[4:7], v13 offset:0
    ds_read_b128 a[8:11], v14 offset:0
    ds_read_b128 a[12:15], v15 offset:0
    s_waitcnt lgkmcnt(5)
    v_mfma_f32_16x16x32_bf16 v[76:79], a[0:3], v[60:63], 0
    s_add_u32 m0, s76, 24576
    ds_read_b64_tr_b16 v[68:69], v20 offset:1024
    s_add_u32 s72, s65, 3
    v_mfma_f32_16x16x32_bf16 v[136:139], a[0:3], v[24:27], 0
    s_and_b32 s72, s72, 7
    ds_read_b64_tr_b16 v[70:71], v20 offset:1536
    s_lshl_b32 s73, s72, 7
    v_mfma_f32_16x16x32_bf16 v[140:143], a[0:3], a[0:3], 0
    s_add_u32 s73, s73, s70
    ds_read_b128 a[16:19], v16 offset:0
    v_lshlrev_b32 v54, 5, v47
    v_mfma_f32_16x16x32_bf16 v[124:127], v[24:27], v[60:63], 0
    s_waitcnt lgkmcnt(6)
    ds_read_b64_tr_b16 v[72:73], v20 offset:3072
    v_lshl_add_u32 v54, v50, 4, v54
    v_mfma_f32_16x16x32_bf16 v[92:95], a[0:3], v[64:67], 0
    ds_read_b64_tr_b16 v[74:75], v20 offset:3584
    v_lshl_add_u32 v54, v48, 3, v54
    v_mfma_f32_16x16x32_bf16 v[128:131], v[24:27], v[64:67], 0
    s_waitcnt lgkmcnt(7)
    ds_read_b128 a[20:23], v17 offset:0
    v_lshl_add_u32 v54, v46, 7, v54
    v_mfma_f32_16x16x32_bf16 v[80:83], a[4:7], v[60:63], 0
    ds_read_b128 a[24:27], v18 offset:0
    v_lshl_add_u32 v54, v49, 10, v54
    v_mfma_f32_16x16x32_bf16 v[96:99], a[4:7], v[64:67], 0
    s_waitcnt lgkmcnt(8)
    ds_read_b128 a[28:31], v19 offset:0
    s_mov_b64 s[36:37], s[8:9]
    v_mfma_f32_16x16x32_bf16 v[84:87], a[8:11], v[60:63], 0
    s_mov_b32 s38, 524288
    buffer_load_dwordx4 v6, s[24:27], s73 offen lds
    v_mfma_f32_16x16x32_bf16 v[100:103], a[8:11], v[64:67], 0
    s_waitcnt lgkmcnt(8)
    buffer_load_dwordx4 v7, s[24:27], s73 offen offset:1024 lds
    v_mfma_f32_16x16x32_bf16 v[88:91], a[12:15], v[60:63], 0
    s_mov_b32 s39, 0x20000
    s_mov_b32 s54, 2097152
    s_mov_b32 s55, 0x20000
    v_mfma_f32_16x16x32_bf16 v[104:107], a[12:15], v[64:67], 0
    s_and_b32 s3, s62, 3
    s_lshr_b32 s67, s62, 2
    s_lshl2_add_u32 s66, s61, s3
    s_waitcnt vmcnt(8) lgkmcnt(5)
    s_barrier
    s_cmp_ge_u32 s2, 16
    s_cbranch_scc1 L_sk_3
    s_cmp_lg_u32 s60, 0
    s_cbranch_scc1 L_sk_4
    s_mov_b64 exec, 1
    buffer_atomic_add v23, v22, s[56:59], 0 offen sc1
    s_mov_b64 exec, -1
L_sk_4:
L_sk_3:
    v_mfma_f32_16x16x32_bf16 v[76:79], a[16:19], v[68:71], v[76:79]
    s_add_u32 m0, s77, 49152
    ds_read_b64_tr_b16 v[60:61], v20 offset:16384
    s_lshr_b32 s18, s61, 1
    v_mfma_f32_16x16x32_bf16 v[136:139], a[16:19], v[24:27], v[136:139]
    s_add_u32 s72, s65, 3
    ds_read_b64_tr_b16 v[62:63], v20 offset:16896
    s_lshl2_add_u32 s68, s18, s3
    v_mfma_f32_16x16x32_bf16 v[140:143], a[16:19], a[16:19], v[140:143]
    s_and_b32 s72, s72, 7
    ds_read_b128 a[32:35], v12 offset:8192
    s_lshl3_add_u32 s69, s81, s67
    v_mfma_f32_16x16x32_bf16 v[124:127], v[24:27], v[68:71], v[124:127]
    s_waitcnt lgkmcnt(6)
    ds_read_b64_tr_b16 v[64:65], v20 offset:18432
    s_lshl2_add_u32 s78, s64, s60
    v_mfma_f32_16x16x32_bf16 v[92:95], a[16:19], v[72:75], v[92:95]
    s_mul_i32 s73, s72, 196608
    ds_read_b64_tr_b16 v[66:67], v20 offset:18944
    s_lshl2_add_u32 s88, s68, s60
    v_mfma_f32_16x16x32_bf16 v[128:131], v[24:27], v[72:75], v[128:131]
    s_waitcnt lgkmcnt(7)
    ds_read_b128 a[36:39], v13 offset:8192
    s_mov_b32 s96, 0x358637bd
    v_mfma_f32_16x16x32_bf16 v[80:83], a[20:23], v[68:71], v[80:83]
    s_add_u32 s73, s73, s71
    ds_read_b128 a[40:43], v14 offset:8192
    s_mov_b32 s97, 0x358637bd
    v_mfma_f32_16x16x32_bf16 v[96:99], a[20:23], v[72:75], v[96:99]
    s_waitcnt lgkmcnt(8)
    ds_read_b128 a[44:47], v15 offset:8192
    s_mov_b32 s98, 0x3fb8aa3b
    v_mfma_f32_16x16x32_bf16 v[84:87], a[24:27], v[68:71], v[84:87]
    s_mov_b32 s99, 0x3fb8aa3b
    buffer_load_dwordx4 v8, s[28:31], s73 offen lds
    v_mfma_f32_16x16x32_bf16 v[100:103], a[24:27], v[72:75], v[100:103]
    s_waitcnt lgkmcnt(8)
    buffer_load_dwordx4 v9, s[28:31], s73 offen offset:1024 lds
    v_mfma_f32_16x16x32_bf16 v[88:91], a[28:31], v[68:71], v[88:91]
    s_lshl_b32 s16, s60, 6
    buffer_load_dwordx4 v10, s[28:31], s73 offen offset:2048 lds
    v_mfma_f32_16x16x32_bf16 v[104:107], a[28:31], v[72:75], v[104:107]
    s_waitcnt lgkmcnt(5)
    buffer_load_dwordx4 v11, s[28:31], s73 offen offset:3072 lds
    v_mfma_f32_16x16x32_bf16 v[76:79], a[32:35], v[60:63], v[76:79]
    s_add_u32 m0, s76, 32768
    ds_read_b64_tr_b16 v[68:69], v20 offset:17408
    s_add_u32 s16, s16, 147456
    v_mfma_f32_16x16x32_bf16 v[136:139], a[32:35], v[24:27], v[136:139]
    s_add_u32 s72, s65, 4
    ds_read_b64_tr_b16 v[70:71], v20 offset:17920
    v_lshl_add_u32 v42, v44, 2, s16
    v_mfma_f32_16x16x32_bf16 v[140:143], a[32:35], a[32:35], v[140:143]
    s_and_b32 s72, s72, 7
    ds_read_b128 a[48:51], v16 offset:8192
    v_lshl_add_u32 v41, v45, 4, s16
    v_mfma_f32_16x16x32_bf16 v[124:127], v[24:27], v[60:63], v[124:127]
    s_waitcnt lgkmcnt(6)
    ds_read_b64_tr_b16 v[72:73], v20 offset:19456
    v_xor_b32 v3, s60, v45
    v_mfma_f32_16x16x32_bf16 v[92:95], a[32:35], v[64:67], v[92:95]
    s_lshl_b32 s73, s72, 7
    ds_read_b64_tr_b16 v[74:75], v20 offset:19968
    v_and_b32 v3, 1, v3
    v_mfma_f32_16x16x32_bf16 v[128:131], v[24:27], v[64:67], v[128:131]
    s_waitcnt lgkmcnt(7)
    ds_read_b128 a[52:55], v17 offset:8192
    v_lshl_add_u32 v3, v3, 4, v44
    v_mfma_f32_16x16x32_bf16 v[80:83], a[36:39], v[60:63], v[80:83]
    s_add_u32 s73, s73, s70
    ds_read_b128 a[56:59], v18 offset:8192
    v_lshlrev_b32 v3, 5, v3
    v_mfma_f32_16x16x32_bf16 v[96:99], a[36:39], v[64:67], v[96:99]
    s_waitcnt lgkmcnt(8)
    ds_read_b128 a[60:63], v19 offset:8192
    v_lshl_add_u32 v248, v49, 4, v3
    v_mfma_f32_16x16x32_bf16 v[84:87], a[40:43], v[60:63], v[84:87]
    buffer_load_dwordx4 v6, s[24:27], s73 offen lds
    v_mfma_f32_16x16x32_bf16 v[100:103], a[40:43], v[64:67], v[100:103]
    s_waitcnt lgkmcnt(8)
    buffer_load_dwordx4 v7, s[24:27], s73 offen offset:1024 lds
    v_mfma_f32_16x16x32_bf16 v[88:91], a[44:47], v[60:63], v[88:91]
    v_and_b32 v4, 2, v52
    v_lshlrev_b32 v4, 1, v4
    v_mfma_f32_16x16x32_bf16 v[104:107], a[44:47], v[64:67], v[104:107]
    v_xor_b32 v3, v53, v4
    v_lshlrev_b32 v3, 4, v3
    s_waitcnt vmcnt(8) lgkmcnt(5)
    s_barrier
    v_mfma_f32_16x16x32_bf16 v[76:79], a[48:51], v[68:71], v[76:79]
    s_add_u32 m0, s77, 0
    ds_read_b64_tr_b16 v[60:61], v20 offset:32768
    v_lshl_add_u32 v28, v52, 10, v3
    v_mfma_f32_16x16x32_bf16 v[136:139], a[48:51], v[24:27], v[136:139]
    s_add_u32 s72, s65, 4
    ds_read_b64_tr_b16 v[62:63], v20 offset:33280
    v_add_u32 v29, 7168, v28
    v_mfma_f32_16x16x32_bf16 v[140:143], a[48:51], a[48:51], v[140:143]
    s_and_b32 s72, s72, 7
    ds_read_b128 a[64:67], v12 offset:16384
    v_add_u32 v30, 14336, v28
    v_mfma_f32_16x16x32_bf16 v[124:127], v[24:27], v[68:71], v[124:127]
    s_waitcnt lgkmcnt(6)
    ds_read_b64_tr_b16 v[64:65], v20 offset:34816
    v_add_u32 v31, 21504, v28
    v_mfma_f32_16x16x32_bf16 v[92:95], a[48:51], v[72:75], v[92:95]
    s_mul_i32 s73, s72, 196608
    ds_read_b64_tr_b16 v[66:67], v20 offset:35328
    v_lshrrev_b32 v2, 1, v46
    v_mfma_f32_16x16x32_bf16 v[128:131], v[24:27], v[72:75], v[128:131]
    s_waitcnt lgkmcnt(7)
    ds_read_b128 a[68:71], v13 offset:16384
    s_lshr_b32 s16, s60, 1
    v_mfma_f32_16x16x32_bf16 v[80:83], a[52:55], v[68:71], v[80:83]
    s_add_u32 s73, s73, s71
    ds_read_b128 a[72:75], v14 offset:16384
    v_xor_b32 v2, s16, v2
    v_mfma_f32_16x16x32_bf16 v[96:99], a[52:55], v[72:75], v[96:99]
    s_waitcnt lgkmcnt(8)
    ds_read_b128 a[76:79], v15 offset:16384
    v_lshl_add_u32 v3, v2, 6, v54
    v_mfma_f32_16x16x32_bf16 v[84:87], a[56:59], v[68:71], v[84:87]
    s_lshr_b32 s17, s60, 1
    buffer_load_dwordx4 v8, s[28:31], s73 offen lds
    v_mfma_f32_16x16x32_bf16 v[100:103], a[56:59], v[72:75], v[100:103]
    s_waitcnt lgkmcnt(8)
    buffer_load_dwordx4 v9, s[28:31], s73 offen offset:1024 lds
    v_mfma_f32_16x16x32_bf16 v[88:91], a[60:63], v[68:71], v[88:91]
    s_lshl_b32 s17, s17, 15
    buffer_load_dwordx4 v10, s[28:31], s73 offen offset:2048 lds
    v_mfma_f32_16x16x32_bf16 v[104:107], a[60:63], v[72:75], v[104:107]
    s_waitcnt lgkmcnt(5)
    buffer_load_dwordx4 v11, s[28:31], s73 offen offset:3072 lds
    v_mfma_f32_16x16x32_bf16 v[76:79], a[64:67], v[60:63], v[76:79]
    s_add_u32 m0, s76, 40960
    ds_read_b64_tr_b16 v[68:69], v20 offset:33792
    s_add_u32 s9, s17, 32768
    v_mfma_f32_16x16x32_bf16 v[136:139], a[64:67], v[24:27], v[136:139]
    s_add_u32 s72, s65, 5
    ds_read_b64_tr_b16 v[70:71], v20 offset:34304
    s_lshl_b32 s16, s60, 14
    v_mfma_f32_16x16x32_bf16 v[140:143], a[64:67], a[64:67], v[140:143]
    s_and_b32 s72, s72, 7
    ds_read_b128 a[80:83], v16 offset:16384
    s_add_u32 s16, s16, s9
    v_mfma_f32_16x16x32_bf16 v[124:127], v[24:27], v[60:63], v[124:127]
    s_waitcnt lgkmcnt(6)
    ds_read_b64_tr_b16 v[72:73], v20 offset:35840
    v_add_u32 v32, s16, v3
    v_mfma_f32_16x16x32_bf16 v[92:95], a[64:67], v[64:67], v[92:95]
    s_lshl_b32 s73, s72, 7
    ds_read_b64_tr_b16 v[74:75], v20 offset:36352
    v_subrev_u32 v185, 65536, v20
    v_mfma_f32_16x16x32_bf16 v[128:131], v[24:27], v[64:67], v[128:131]
    s_waitcnt lgkmcnt(7)
    ds_read_b128 a[84:87], v17 offset:16384
    v_xor_b32 v33, 64, v32
    v_mfma_f32_16x16x32_bf16 v[80:83], a[68:71], v[60:63], v[80:83]
    s_add_u32 s73, s73, s70
    ds_read_b128 a[88:91], v18 offset:16384
    v_lshlrev_b32 v3, 5, v49
    v_mfma_f32_16x16x32_bf16 v[96:99], a[68:71], v[64:67], v[96:99]
    s_waitcnt lgkmcnt(8)
    ds_read_b128 a[92:95], v19 offset:16384
    v_lshl_add_u32 v240, v51, 10, v3
    v_mfma_f32_16x16x32_bf16 v[84:87], a[72:75], v[60:63], v[84:87]
    s_and_b32 s16, s60, 1
    buffer_load_dwordx4 v6, s[24:27], s73 offen lds
    v_mfma_f32_16x16x32_bf16 v[100:103], a[72:75], v[64:67], v[100:103]
    s_waitcnt lgkmcnt(8)
    buffer_load_dwordx4 v7, s[24:27], s73 offen offset:1024 lds
    v_mfma_f32_16x16x32_bf16 v[88:91], a[76:79], v[60:63], v[88:91]
    s_lshl1_add_u32 s16, s66, s16
    s_lshl_b32 s83, s16, 15
    s_lshr_b32 s17, s60, 1
    v_mfma_f32_16x16x32_bf16 v[104:107], a[76:79], v[64:67], v[104:107]
    s_lshl1_add_u32 s17, s67, s17
    s_lshl_b32 s17, s17, 6
    s_add_u32 s83, s83, s17
    s_waitcnt vmcnt(8) lgkmcnt(5)
    s_barrier
    v_mfma_f32_16x16x32_bf16 v[76:79], a[80:83], v[68:71], v[76:79]
    s_add_u32 m0, s77, 16384
    ds_read_b64_tr_b16 v[60:61], v20 offset:49152
    v_cmp_gt_u32 vcc, 8, v1
    v_mfma_f32_16x16x32_bf16 v[136:139], a[80:83], v[24:27], v[136:139]
    s_add_u32 s72, s65, 5
    ds_read_b64_tr_b16 v[62:63], v20 offset:49664
    s_lshl_b32 s16, s64, 7
    v_mfma_f32_16x16x32_bf16 v[140:143], a[80:83], a[80:83], v[140:143]
    s_and_b32 s72, s72, 7
    ds_read_b128 a[96:99], v12 offset:24576
    v_lshlrev_b32 v241, 10, v1
    v_mfma_f32_16x16x32_bf16 v[124:127], v[24:27], v[68:71], v[124:127]
    s_waitcnt lgkmcnt(6)
    ds_read_b64_tr_b16 v[64:65], v20 offset:51200
    v_add_u32 v241, s16, v241
    v_mfma_f32_16x16x32_bf16 v[92:95], a[80:83], v[72:75], v[92:95]
    s_mul_i32 s73, s72, 196608
    ds_read_b64_tr_b16 v[66:67], v20 offset:51712
    s_add_u32 s16, s63, 64
    v_mfma_f32_16x16x32_bf16 v[128:131], v[24:27], v[72:75], v[128:131]
    s_waitcnt lgkmcnt(7)
    ds_read_b128 a[100:103], v13 offset:24576
    s_lshl_b32 s16, s16, 7
    v_mfma_f32_16x16x32_bf16 v[80:83], a[84:87], v[68:71], v[80:83]
    s_add_u32 s73, s73, s71
    ds_read_b128 a[104:107], v14 offset:24576
    v_mov_b32 v2, s16
    v_mfma_f32_16x16x32_bf16 v[96:99], a[84:87], v[72:75], v[96:99]
    s_waitcnt lgkmcnt(8)
    ds_read_b128 a[108:111], v15 offset:24576
    v_cndmask_b32 v241, v2, v241, vcc
    v_mfma_f32_16x16x32_bf16 v[84:87], a[88:91], v[68:71], v[84:87]
    s_lshl_b32 s16, s61, 10
    buffer_load_dwordx4 v8, s[28:31], s73 offen lds
    v_mfma_f32_16x16x32_bf16 v[100:103], a[88:91], v[72:75], v[100:103]
    s_waitcnt lgkmcnt(8)
    buffer_load_dwordx4 v9, s[28:31], s73 offen offset:1024 lds
    v_mfma_f32_16x16x32_bf16 v[88:91], a[92:95], v[68:71], v[88:91]
    buffer_load_dwordx4 v10, s[28:31], s73 offen offset:2048 lds
    v_mfma_f32_16x16x32_bf16 v[104:107], a[92:95], v[72:75], v[104:107]
    s_waitcnt lgkmcnt(5)
    buffer_load_dwordx4 v11, s[28:31], s73 offen offset:3072 lds
    v_mfma_f32_16x16x32_bf16 v[76:79], a[96:99], v[60:63], v[76:79]
    s_add_u32 m0, s76, 49152
    ds_read_b64_tr_b16 v[68:69], v20 offset:50176
    v_and_b32 v249, 0x380, v242
    v_mfma_f32_16x16x32_bf16 v[136:139], a[96:99], v[24:27], v[136:139]
    s_add_u32 s72, s65, 6
    ds_read_b64_tr_b16 v[70:71], v20 offset:50688
    v_add_u32 v249, s16, v249
    v_mfma_f32_16x16x32_bf16 v[140:143], a[96:99], a[96:99], v[140:143]
    s_and_b32 s72, s72, 7
    ds_read_b128 a[112:115], v16 offset:24576
    v_lshlrev_b32 v4, 4, v49
    v_mfma_f32_16x16x32_bf16 v[124:127], v[24:27], v[60:63], v[124:127]
    s_waitcnt lgkmcnt(6)
    ds_read_b64_tr_b16 v[72:73], v20 offset:52224
    v_lshl_add_u32 v244, v51, 5, v4
    v_mfma_f32_16x16x32_bf16 v[92:95], a[96:99], v[64:67], v[92:95]
    s_lshl_b32 s73, s72, 7
    ds_read_b64_tr_b16 v[74:75], v20 offset:52736
    v_lshlrev_b32 v247, 2, v51
    v_mfma_f32_16x16x32_bf16 v[128:131], v[24:27], v[64:67], v[128:131]
    s_waitcnt lgkmcnt(7)
    ds_read_b128 a[116:119], v17 offset:24576
    v_add_u32 v247, 151552, v247
    v_mfma_f32_16x16x32_bf16 v[80:83], a[100:103], v[60:63], v[80:83]
    s_add_u32 s73, s73, s70
    ds_read_b128 a[120:123], v18 offset:24576
    v_min_u32 v4, 16, v51
    v_mfma_f32_16x16x32_bf16 v[96:99], a[100:103], v[64:67], v[96:99]
    s_waitcnt lgkmcnt(8)
    ds_read_b128 a[124:127], v19 offset:24576
    v_add_u32 v246, 0x10000, v21
    v_mfma_f32_16x16x32_bf16 v[84:87], a[104:107], v[60:63], v[84:87]
    buffer_load_dwordx4 v6, s[24:27], s73 offen lds
    v_mfma_f32_16x16x32_bf16 v[100:103], a[104:107], v[64:67], v[100:103]
    s_waitcnt lgkmcnt(8)
    buffer_load_dwordx4 v7, s[24:27], s73 offen offset:1024 lds
    v_mfma_f32_16x16x32_bf16 v[88:91], a[108:111], v[60:63], v[88:91]
    v_lshlrev_b32 v4, 6, v4
    v_lshl_add_u32 v245, v49, 5, v4
    v_mfma_f32_16x16x32_bf16 v[104:107], a[108:111], v[64:67], v[104:107]
    v_lshlrev_b32 v4, 9, v50
    v_lshl_add_u32 v4, v49, 8, v4
    s_waitcnt vmcnt(8) lgkmcnt(5)
    s_barrier
    v_mfma_f32_16x16x32_bf16 v[76:79], a[112:115], v[68:71], v[76:79]
    s_add_u32 m0, s77, 32768
    ds_read_b64_tr_b16 v[60:61], v20 offset:0
    v_lshl_add_u32 v43, v44, 2, v4
    v_mfma_f32_16x16x32_bf16 v[136:139], a[112:115], v[24:27], v[136:139]
    s_add_u32 s72, s65, 6
    ds_read_b64_tr_b16 v[62:63], v20 offset:512
    s_lshr_b32 s18, 0x1133, s69
    v_mfma_f32_16x16x32_bf16 v[140:143], a[112:115], a[112:115], v[140:143]
    s_and_b32 s72, s72, 7
    ds_read_b128 a[128:131], v12 offset:32768
    s_mul_i32 s73, s72, 196608
    v_mfma_f32_16x16x32_bf16 v[124:127], v[24:27], v[68:71], v[124:127]
    s_waitcnt lgkmcnt(6)
    ds_read_b64_tr_b16 v[64:65], v20 offset:2048
    s_add_u32 s73, s73, s71
    v_mfma_f32_16x16x32_bf16 v[92:95], a[112:115], v[72:75], v[92:95]
    s_and_b32 s18, s18, 1
    ds_read_b64_tr_b16 v[66:67], v20 offset:2560
    s_add_u32 s80, s18, 5
    v_mfma_f32_16x16x32_bf16 v[128:131], v[24:27], v[72:75], v[128:131]
    s_waitcnt lgkmcnt(7)
    ds_read_b128 a[132:135], v13 offset:32768
    s_lshl_b32 s18, 1, s69
    v_mfma_f32_16x16x32_bf16 v[80:83], a[116:119], v[68:71], v[80:83]
    s_sub_u32 s18, s18, 1
    ds_read_b128 a[136:139], v14 offset:32768
    s_and_b32 s18, s18, 0x1133
    v_mfma_f32_16x16x32_bf16 v[96:99], a[116:119], v[72:75], v[96:99]
    s_waitcnt lgkmcnt(8)
    ds_read_b128 a[140:143], v15 offset:32768
    s_bcnt1_i32_b32 s18, s18
    v_mfma_f32_16x16x32_bf16 v[84:87], a[120:123], v[68:71], v[84:87]
    s_mul_i32 s79, s69, 5
    buffer_load_dwordx4 v8, s[28:31], s73 offen lds
    v_mfma_f32_16x16x32_bf16 v[100:103], a[120:123], v[72:75], v[100:103]
    s_waitcnt lgkmcnt(8)
    buffer_load_dwordx4 v9, s[28:31], s73 offen offset:1024 lds
    v_mfma_f32_16x16x32_bf16 v[88:91], a[124:127], v[68:71], v[88:91]
    s_add_u32 s79, s79, s18
    buffer_load_dwordx4 v10, s[28:31], s73 offen offset:2048 lds
    v_mfma_f32_16x16x32_bf16 v[104:107], a[124:127], v[72:75], v[104:107]
    s_waitcnt lgkmcnt(5)
    buffer_load_dwordx4 v11, s[28:31], s73 offen offset:3072 lds
    v_mfma_f32_16x16x32_bf16 v[76:79], a[128:131], v[60:63], v[76:79]
    s_add_u32 m0, s76, 57344
    ds_read_b64_tr_b16 v[68:69], v20 offset:1024
    v_mfma_f32_16x16x32_bf16 v[136:139], a[128:131], v[24:27], v[136:139]
    s_add_u32 s72, s65, 7
    ds_read_b64_tr_b16 v[70:71], v20 offset:1536
    v_mfma_f32_16x16x32_bf16 v[140:143], a[128:131], a[128:131], v[140:143]
    s_and_b32 s72, s72, 7
    ds_read_b128 a[144:147], v16 offset:32768
    v_mfma_f32_16x16x32_bf16 v[124:127], v[24:27], v[60:63], v[124:127]
    s_waitcnt lgkmcnt(6)
    ds_read_b64_tr_b16 v[72:73], v20 offset:3072
    v_mfma_f32_16x16x32_bf16 v[92:95], a[128:131], v[64:67], v[92:95]
    s_lshl_b32 s73, s72, 7
    ds_read_b64_tr_b16 v[74:75], v20 offset:3584
    v_mfma_f32_16x16x32_bf16 v[128:131], v[24:27], v[64:67], v[128:131]
    s_waitcnt lgkmcnt(7)
    ds_read_b128 a[148:151], v17 offset:32768
    v_mfma_f32_16x16x32_bf16 v[80:83], a[132:135], v[60:63], v[80:83]
    s_add_u32 s73, s73, s70
    ds_read_b128 a[152:155], v18 offset:32768
    v_mfma_f32_16x16x32_bf16 v[96:99], a[132:135], v[64:67], v[96:99]
    s_waitcnt lgkmcnt(8)
    ds_read_b128 a[156:159], v19 offset:32768
    v_mfma_f32_16x16x32_bf16 v[84:87], a[136:139], v[60:63], v[84:87]
    buffer_load_dwordx4 v6, s[24:27], s73 offen lds
    v_mfma_f32_16x16x32_bf16 v[100:103], a[136:139], v[64:67], v[100:103]
    s_waitcnt lgkmcnt(8)
    buffer_load_dwordx4 v7, s[24:27], s73 offen offset:1024 lds
    v_mfma_f32_16x16x32_bf16 v[88:91], a[140:143], v[60:63], v[88:91]
    v_mfma_f32_16x16x32_bf16 v[104:107], a[140:143], v[64:67], v[104:107]
    s_waitcnt vmcnt(8) lgkmcnt(5)
    s_barrier
    v_mfma_f32_16x16x32_bf16 v[76:79], a[144:147], v[68:71], v[76:79]
    s_add_u32 m0, s77, 49152
    ds_read_b64_tr_b16 v[60:61], v20 offset:16384
    v_mfma_f32_16x16x32_bf16 v[136:139], a[144:147], v[24:27], v[136:139]
    s_add_u32 s72, s65, 7
    ds_read_b64_tr_b16 v[62:63], v20 offset:16896
    v_mfma_f32_16x16x32_bf16 v[140:143], a[144:147], a[144:147], v[140:143]
    s_and_b32 s72, s72, 7
    ds_read_b128 a[160:163], v12 offset:40960
    v_mfma_f32_16x16x32_bf16 v[124:127], v[24:27], v[68:71], v[124:127]
    s_waitcnt lgkmcnt(6)
    ds_read_b64_tr_b16 v[64:65], v20 offset:18432
    v_mfma_f32_16x16x32_bf16 v[92:95], a[144:147], v[72:75], v[92:95]
    s_mul_i32 s73, s72, 196608
    ds_read_b64_tr_b16 v[66:67], v20 offset:18944
    v_mfma_f32_16x16x32_bf16 v[128:131], v[24:27], v[72:75], v[128:131]
    s_waitcnt lgkmcnt(7)
    ds_read_b128 a[164:167], v13 offset:40960
    v_mfma_f32_16x16x32_bf16 v[80:83], a[148:151], v[68:71], v[80:83]
    s_add_u32 s73, s73, s71
    ds_read_b128 a[168:171], v14 offset:40960
    v_mfma_f32_16x16x32_bf16 v[96:99], a[148:151], v[72:75], v[96:99]
    s_waitcnt lgkmcnt(8)
    ds_read_b128 a[172:175], v15 offset:40960
    v_mfma_f32_16x16x32_bf16 v[84:87], a[152:155], v[68:71], v[84:87]
    buffer_load_dwordx4 v8, s[28:31], s73 offen lds
    v_mfma_f32_16x16x32_bf16 v[100:103], a[152:155], v[72:75], v[100:103]
    s_waitcnt lgkmcnt(8)
    buffer_load_dwordx4 v9, s[28:31], s73 offen offset:1024 lds
    v_mfma_f32_16x16x32_bf16 v[88:91], a[156:159], v[68:71], v[88:91]
    buffer_load_dwordx4 v10, s[28:31], s73 offen offset:2048 lds
    v_mfma_f32_16x16x32_bf16 v[104:107], a[156:159], v[72:75], v[104:107]
    s_waitcnt lgkmcnt(5)
    buffer_load_dwordx4 v11, s[28:31], s73 offen offset:3072 lds
    v_mfma_f32_16x16x32_bf16 v[76:79], a[160:163], v[60:63], v[76:79]
    s_sub_u32 m0, s77, 65536
    ds_read_b64_tr_b16 v[68:69], v20 offset:17408
    v_mfma_f32_16x16x32_bf16 v[136:139], a[160:163], v[24:27], v[136:139]
    s_add_u32 s72, s65, 0
    ds_read_b64_tr_b16 v[70:71], v20 offset:17920
    v_mfma_f32_16x16x32_bf16 v[140:143], a[160:163], a[160:163], v[140:143]
    s_and_b32 s72, s72, 7
    ds_read_b128 a[176:179], v16 offset:40960
    v_mfma_f32_16x16x32_bf16 v[124:127], v[24:27], v[60:63], v[124:127]
    s_waitcnt lgkmcnt(6)
    ds_read_b64_tr_b16 v[72:73], v20 offset:19456
    v_mfma_f32_16x16x32_bf16 v[92:95], a[160:163], v[64:67], v[92:95]
    s_mul_i32 s73, s72, 196608
    ds_read_b64_tr_b16 v[74:75], v20 offset:19968
    v_mfma_f32_16x16x32_bf16 v[128:131], v[24:27], v[64:67], v[128:131]
    s_waitcnt lgkmcnt(7)
    ds_read_b128 a[180:183], v17 offset:40960
    v_mfma_f32_16x16x32_bf16 v[80:83], a[164:167], v[60:63], v[80:83]
    s_add_u32 s73, s73, s71
    ds_read_b128 a[184:187], v18 offset:40960
    v_mfma_f32_16x16x32_bf16 v[96:99], a[164:167], v[64:67], v[96:99]
    s_waitcnt lgkmcnt(8)
    ds_read_b128 a[188:191], v19 offset:40960
    v_mfma_f32_16x16x32_bf16 v[84:87], a[168:171], v[60:63], v[84:87]
    buffer_load_dwordx4 v10, s[28:31], s73 offen lds
    v_mfma_f32_16x16x32_bf16 v[100:103], a[168:171], v[64:67], v[100:103]
    s_waitcnt lgkmcnt(8)
    buffer_load_dwordx4 v11, s[28:31], s73 offen offset:1024 lds
    v_mfma_f32_16x16x32_bf16 v[88:91], a[172:175], v[60:63], v[88:91]
    s_sub_u32 m0, s77, 63488
    s_add_u32 s72, s65, 1
    s_and_b32 s72, s72, 7
    v_mfma_f32_16x16x32_bf16 v[104:107], a[172:175], v[64:67], v[104:107]
    s_mul_i32 s73, s72, 196608
    s_add_u32 s73, s73, s71
    buffer_load_dwordx4 v10, s[28:31], s73 offen lds
    buffer_load_dwordx4 v11, s[28:31], s73 offen offset:1024 lds
    buffer_load_dword v251, off, s[56:59], 0 sc1
    s_mov_b32 s50, 1409024
    s_mov_b32 s51, 0x20000
    s_mov_b32 s43, 0x20000
    s_mov_b32 s47, 0x20000
    s_cmp_ge_u32 s2, 176
    s_cbranch_scc1 L_rtB_5
    s_mov_b64 s[40:41], s[12:13]
    s_mov_b64 s[44:45], s[14:15]
    s_mov_b32 s42, 1409024
    s_mov_b32 s46, 1409024
    s_and_b32 s72, s2, 7
    s_lshl2_add_u32 s73, s72, s60
    s_mul_i32 s73, s73, 44032
    s_lshr_b32 s74, s2, 3
    s_lshl_b32 s75, s74, 7
    s_add_u32 s89, s73, s75
    s_mov_b32 s90, s89
    v_mul_u32_u24 v2, 2752, v52
    v_lshl_add_u32 v34, v53, 4, v2
    v_add_u32 v35, 20992, v34
    v_lshlrev_b32 v2, 7, v46
    v_lshl_add_u32 v2, v49, 12, v2
    v_lshl_add_u32 v2, v50, 4, v2
    v_lshl_add_u32 v2, v48, 11, v2
    v_lshl_add_u32 v2, v47, 3, v2
    s_lshl_b32 s75, s60, 5
    s_add_u32 s75, s75, 131072
    v_add_u32 v36, s75, v2
    v_add_u32 v37, 1024, v36
    v_add_u32 v38, 8192, v36
    v_add_u32 v39, 9216, v36
    s_lshl2_add_u32 s74, s74, s60
    s_lshl3_add_u32 s72, s74, s72
    s_lshl_b32 s73, s72, 7
    s_add_u32 s73, s73, 393216
    s_lshl_b32 s72, s72, 12
    s_add_u32 s72, s72, 5242880
    s_cmp_lt_u32 s74, 86
    s_cselect_b32 s91, s72, 0
    s_cselect_b32 s92, s73, 0
    s_branch L_rtJ_6
L_rtB_5:
    s_mov_b64 s[40:41], s[48:49]
    s_mov_b64 s[44:45], s[48:49]
    s_mov_b32 s42, 1409024
    s_mov_b32 s46, 1409024
    s_sub_u32 s72, s2, 176
    s_lshl_b32 s73, s72, 14
    s_lshl_b32 s74, s60, 8
    s_add_u32 s89, s73, s74
    s_add_u32 s90, s89, 128
    v_and_b32 v2, 3, v52
    v_lshrrev_b32 v3, 2, v52
    v_lshl_add_u32 v2, v3, 3, v2
    v_lshlrev_b32 v2, 10, v2
    v_lshl_add_u32 v34, v53, 4, v2
    v_add_u32 v35, 3072, v34
    s_lshl_b32 s75, s60, 12
    s_add_u32 s74, s75, 131072
    v_add_u32 v36, s74, v54
    v_add_u32 v37, 64, v36
    v_add_u32 v38, 2048, v36
    v_add_u32 v39, 2112, v36
    s_add_u32 s73, s73, s75
    s_add_u32 s91, s73, 8126464
    s_mov_b32 s92, 0
L_rtJ_6:
    s_sub_u32 s72, s2, 176
    s_lshr_b32 s73, s72, 3
    s_add_u32 s73, s73, 80
    s_and_b32 s74, s72, 7
    s_lshl_b32 s73, s73, 14
    s_lshl_b32 s75, s74, 7
    s_add_u32 s93, s73, s75
    s_lshl_b32 s75, s60, 12
    s_add_u32 s93, s93, s75
    s_lshl1_add_u32 s74, s74, s60
    s_lshl_b32 s74, s74, 10
    s_add_u32 s73, s73, s74
    s_add_u32 s73, s73, 8126464
    s_cmp_lt_u32 s72, 48
    s_cselect_b32 s94, s73, 0
    s_cmp_lt_u32 s60, 2
    s_cselect_b32 s94, s94, 0
    s_lshl_b32 s75, s60, 6
    s_add_u32 s75, s75, 148480
    v_add_u32 v40, s75, v54
    s_waitcnt vmcnt(11) lgkmcnt(5)
    s_barrier
    v_mfma_f32_16x16x32_bf16 v[76:79], a[176:179], v[68:71], v[76:79]
    s_sub_u32 m0, s77, 49152
    ds_read_b64_tr_b16 v[60:61], v20 offset:32768
    v_mfma_f32_16x16x32_bf16 v[136:139], a[176:179], v[24:27], v[136:139]
    s_add_u32 s72, s65, 2
    ds_read_b64_tr_b16 v[62:63], v20 offset:33280
    v_mfma_f32_16x16x32_bf16 v[140:143], a[176:179], a[176:179], v[140:143]
    s_and_b32 s72, s72, 7
    ds_read_b128 a[192:195], v12 offset:49152
    v_mfma_f32_16x16x32_bf16 v[124:127], v[24:27], v[68:71], v[124:127]
    s_waitcnt lgkmcnt(6)
    ds_read_b64_tr_b16 v[64:65], v20 offset:34816
    v_mfma_f32_16x16x32_bf16 v[92:95], a[176:179], v[72:75], v[92:95]
    s_mul_i32 s73, s72, 196608
    ds_read_b64_tr_b16 v[66:67], v20 offset:35328
    v_mfma_f32_16x16x32_bf16 v[128:131], v[24:27], v[72:75], v[128:131]
    s_waitcnt lgkmcnt(7)
    ds_read_b128 a[196:199], v13 offset:49152
    v_mfma_f32_16x16x32_bf16 v[80:83], a[180:183], v[68:71], v[80:83]
    s_add_u32 s73, s73, s71
    ds_read_b128 a[200:203], v14 offset:49152
    v_mfma_f32_16x16x32_bf16 v[96:99], a[180:183], v[72:75], v[96:99]
    s_waitcnt lgkmcnt(8)
    ds_read_b128 a[204:207], v15 offset:49152
    v_mfma_f32_16x16x32_bf16 v[84:87], a[184:187], v[68:71], v[84:87]
    buffer_load_dwordx4 v10, s[28:31], s73 offen lds
    v_mfma_f32_16x16x32_bf16 v[100:103], a[184:187], v[72:75], v[100:103]
    s_waitcnt lgkmcnt(8)
    buffer_load_dwordx4 v11, s[28:31], s73 offen offset:1024 lds
    v_mfma_f32_16x16x32_bf16 v[88:91], a[188:191], v[68:71], v[88:91]
    s_sub_u32 m0, s77, 47104
    s_add_u32 s72, s65, 3
    s_and_b32 s72, s72, 7
    v_mfma_f32_16x16x32_bf16 v[104:107], a[188:191], v[72:75], v[104:107]
    s_waitcnt lgkmcnt(5)
    s_mul_i32 s73, s72, 196608
    s_add_u32 s73, s73, s71
    buffer_load_dwordx4 v10, s[28:31], s73 offen lds
    buffer_load_dwordx4 v11, s[28:31], s73 offen offset:1024 lds
    v_mfma_f32_16x16x32_bf16 v[76:79], a[192:195], v[60:63], v[76:79]
    s_add_u32 m0, s77, 0
    ds_read_b64_tr_b16 v[68:69], v20 offset:33792
    v_mfma_f32_16x16x32_bf16 v[136:139], a[192:195], v[24:27], v[136:139]
    s_add_u32 s72, s65, 4
    ds_read_b64_tr_b16 v[70:71], v20 offset:34304
    v_mfma_f32_16x16x32_bf16 v[140:143], a[192:195], a[192:195], v[140:143]
    s_and_b32 s72, s72, 7
    ds_read_b128 a[208:211], v16 offset:49152
    v_mfma_f32_16x16x32_bf16 v[124:127], v[24:27], v[60:63], v[124:127]
    s_waitcnt lgkmcnt(6)
    ds_read_b64_tr_b16 v[72:73], v20 offset:35840
    v_mfma_f32_16x16x32_bf16 v[92:95], a[192:195], v[64:67], v[92:95]
    s_mul_i32 s73, s72, 196608
    ds_read_b64_tr_b16 v[74:75], v20 offset:36352
    v_mfma_f32_16x16x32_bf16 v[128:131], v[24:27], v[64:67], v[128:131]
    s_waitcnt lgkmcnt(7)
    ds_read_b128 a[212:215], v17 offset:49152
    v_mfma_f32_16x16x32_bf16 v[80:83], a[196:199], v[60:63], v[80:83]
    s_add_u32 s73, s73, s71
    ds_read_b128 a[216:219], v18 offset:49152
    v_mfma_f32_16x16x32_bf16 v[96:99], a[196:199], v[64:67], v[96:99]
    s_waitcnt lgkmcnt(8)
    ds_read_b128 a[220:223], v19 offset:49152
    v_mfma_f32_16x16x32_bf16 v[84:87], a[200:203], v[60:63], v[84:87]
    buffer_load_dwordx4 v10, s[28:31], s73 offen lds
    v_mfma_f32_16x16x32_bf16 v[100:103], a[200:203], v[64:67], v[100:103]
    s_waitcnt lgkmcnt(8)
    buffer_load_dwordx4 v11, s[28:31], s73 offen offset:1024 lds
    v_mfma_f32_16x16x32_bf16 v[88:91], a[204:207], v[60:63], v[88:91]
    s_add_u32 m0, s77, 2048
    s_add_u32 s72, s65, 5
    s_and_b32 s72, s72, 7
    v_mfma_f32_16x16x32_bf16 v[104:107], a[204:207], v[64:67], v[104:107]
    s_mul_i32 s73, s72, 196608
    s_add_u32 s73, s73, s71
    buffer_load_dwordx4 v10, s[28:31], s73 offen lds
    buffer_load_dwordx4 v11, s[28:31], s73 offen offset:1024 lds
    s_waitcnt vmcnt(13) lgkmcnt(5)
    s_barrier
    v_mfma_f32_16x16x32_bf16 v[76:79], a[208:211], v[68:71], v[76:79]
    s_add_u32 m0, s77, 16384
    ds_read_b64_tr_b16 v[60:61], v20 offset:49152
    v_mfma_f32_16x16x32_bf16 v[136:139], a[208:211], v[24:27], v[136:139]
    s_add_u32 s72, s65, 6
    ds_read_b64_tr_b16 v[62:63], v20 offset:49664
    v_mfma_f32_16x16x32_bf16 v[140:143], a[208:211], a[208:211], v[140:143]
    s_and_b32 s72, s72, 7
    ds_read_b128 a[224:227], v12 offset:57344
    v_mfma_f32_16x16x32_bf16 v[124:127], v[24:27], v[68:71], v[124:127]
    s_waitcnt lgkmcnt(6)
    ds_read_b64_tr_b16 v[64:65], v20 offset:51200
    v_mfma_f32_16x16x32_bf16 v[92:95], a[208:211], v[72:75], v[92:95]
    s_mul_i32 s73, s72, 196608
    ds_read_b64_tr_b16 v[66:67], v20 offset:51712
    v_mfma_f32_16x16x32_bf16 v[128:131], v[24:27], v[72:75], v[128:131]
    s_waitcnt lgkmcnt(7)
    ds_read_b128 a[228:231], v13 offset:57344
    v_mfma_f32_16x16x32_bf16 v[80:83], a[212:215], v[68:71], v[80:83]
    s_add_u32 s73, s73, s71
    ds_read_b128 a[232:235], v14 offset:57344
    v_mfma_f32_16x16x32_bf16 v[96:99], a[212:215], v[72:75], v[96:99]
    s_waitcnt lgkmcnt(8)
    ds_read_b128 a[236:239], v15 offset:57344
    v_mfma_f32_16x16x32_bf16 v[84:87], a[216:219], v[68:71], v[84:87]
    buffer_load_dwordx4 v10, s[28:31], s73 offen lds
    v_mfma_f32_16x16x32_bf16 v[100:103], a[216:219], v[72:75], v[100:103]
    s_waitcnt lgkmcnt(8)
    buffer_load_dwordx4 v11, s[28:31], s73 offen offset:1024 lds
    v_mfma_f32_16x16x32_bf16 v[88:91], a[220:223], v[68:71], v[88:91]
    s_add_u32 m0, s77, 18432
    s_add_u32 s72, s65, 7
    s_and_b32 s72, s72, 7
    v_mfma_f32_16x16x32_bf16 v[104:107], a[220:223], v[72:75], v[104:107]
    s_waitcnt lgkmcnt(5)
    s_mul_i32 s73, s72, 196608
    s_add_u32 s73, s73, s71
    buffer_load_dwordx4 v10, s[28:31], s73 offen lds
    buffer_load_dwordx4 v11, s[28:31], s73 offen offset:1024 lds
    v_mfma_f32_16x16x32_bf16 v[76:79], a[224:227], v[60:63], v[76:79]
    ds_read_b64_tr_b16 v[68:69], v20 offset:50176
    v_mfma_f32_16x16x32_bf16 v[136:139], a[224:227], v[24:27], v[136:139]
    ds_read_b64_tr_b16 v[70:71], v20 offset:50688
    v_mfma_f32_16x16x32_bf16 v[140:143], a[224:227], a[224:227], v[140:143]
    ds_read_b128 a[240:243], v16 offset:57344
    v_mfma_f32_16x16x32_bf16 v[124:127], v[24:27], v[60:63], v[124:127]
    s_waitcnt lgkmcnt(6)
    ds_read_b64_tr_b16 v[72:73], v20 offset:52224
    v_mfma_f32_16x16x32_bf16 v[92:95], a[224:227], v[64:67], v[92:95]
    ds_read_b64_tr_b16 v[74:75], v20 offset:52736
    v_mfma_f32_16x16x32_bf16 v[128:131], v[24:27], v[64:67], v[128:131]
    s_waitcnt lgkmcnt(7)
    ds_read_b128 a[244:247], v17 offset:57344
    v_mfma_f32_16x16x32_bf16 v[80:83], a[228:231], v[60:63], v[80:83]
    ds_read_b128 a[248:251], v18 offset:57344
    v_mfma_f32_16x16x32_bf16 v[96:99], a[228:231], v[64:67], v[96:99]
    s_waitcnt lgkmcnt(8)
    ds_read_b128 a[252:255], v19 offset:57344
    v_mfma_f32_16x16x32_bf16 v[84:87], a[232:235], v[60:63], v[84:87]
    s_cmp_eq_u32 s94, 0
    s_cbranch_scc1 L_sk_7
    s_lshl_b32 s74, s60, 10
    s_add_u32 m0, s74, 148480
    s_nop 0
    buffer_load_dwordx4 v34, s[48:51], s93 offen lds
L_sk_7:
    v_mfma_f32_16x16x32_bf16 v[100:103], a[232:235], v[64:67], v[100:103]
    s_waitcnt lgkmcnt(8)
    s_add_u32 m0, s77, 65536
    v_mfma_f32_16x16x32_bf16 v[88:91], a[236:239], v[60:63], v[88:91]
    buffer_load_dwordx4 v34, s[40:43], s89 offen lds
    v_mfma_f32_16x16x32_bf16 v[104:107], a[236:239], v[64:67], v[104:107]
    buffer_load_dwordx4 v35, s[40:43], s89 offen offset:1024 lds
    s_add_u32 m0, m0, 2048
    s_nop 0
    buffer_load_dwordx4 v34, s[44:47], s90 offen lds
    buffer_load_dwordx4 v35, s[44:47], s90 offen offset:1024 lds
    s_waitcnt vmcnt(17) lgkmcnt(5)
    s_barrier
    v_mfma_f32_16x16x32_bf16 v[76:79], a[240:243], v[68:71], v[76:79]
    ds_read_b64_tr_b16 v[60:61], v185 offset:0
    v_mfma_f32_16x16x32_bf16 v[136:139], a[240:243], v[24:27], v[136:139]
    ds_read_b64_tr_b16 v[62:63], v185 offset:512
    v_mfma_f32_16x16x32_bf16 v[140:143], a[240:243], a[240:243], v[140:143]
    v_mfma_f32_16x16x32_bf16 v[124:127], v[24:27], v[68:71], v[124:127]
    s_waitcnt lgkmcnt(5)
    v_mfma_f32_16x16x32_bf16 v[92:95], a[240:243], v[72:75], v[92:95]
    v_mfma_f32_16x16x32_bf16 v[128:131], v[24:27], v[72:75], v[128:131]
    s_waitcnt lgkmcnt(4)
    v_mfma_f32_16x16x32_bf16 v[80:83], a[244:247], v[68:71], v[80:83]
    v_mfma_f32_16x16x32_bf16 v[96:99], a[244:247], v[72:75], v[96:99]
    s_waitcnt lgkmcnt(3)
    v_mfma_f32_16x16x32_bf16 v[84:87], a[248:251], v[68:71], v[84:87]
    v_mfma_f32_16x16x32_bf16 v[100:103], a[248:251], v[72:75], v[100:103]
    s_waitcnt lgkmcnt(2)
    v_mfma_f32_16x16x32_bf16 v[88:91], a[252:255], v[68:71], v[88:91]
    v_mfma_f32_16x16x32_bf16 v[104:107], a[252:255], v[72:75], v[104:107]
    v_and_b32 v2, 3, v1
    v_cmp_eq_u32 vcc, 1, v2
    s_nop 1
    v_cndmask_b32 v136, v136, v137, vcc
    v_cndmask_b32 v140, v140, v141, vcc
    v_cmp_eq_u32 vcc, 2, v2
    s_nop 1
    v_cndmask_b32 v136, v136, v138, vcc
    v_cndmask_b32 v140, v140, v142, vcc
    v_cmp_eq_u32 vcc, 3, v2
    s_nop 1
    v_cndmask_b32 v136, v136, v139, vcc
    v_cndmask_b32 v140, v140, v143, vcc
    v_mul_f32 v136, 0x3b000000, v136
    v_mul_f32 v140, 0x3b000000, v140
    v_fma_f32 v140, -v136, v136, v140
    v_max_f32 v140, 0, v140
    v_add_f32 v140, 0x3727c5ac, v140
    v_rsq_f32 v140, v140
    s_mov_b32 exec_lo, 0x00f0000f
    s_mov_b32 exec_hi, 0xf0000f00
    ds_write_b32 v42, v136
    ds_write_b32 v42, v140 offset:256
    s_mov_b64 exec, -1
    ds_read_b64_tr_b16 v[68:69], v185 offset:1024
    ds_read_b64_tr_b16 v[70:71], v185 offset:1536
    s_waitcnt vmcnt(16)
    v_readfirstlane_b32 s73, v251
    v_xor_b32 v190, 0, v41
    v_xor_b32 v194, 0, v42
    v_xor_b32 v191, 64, v41
    v_xor_b32 v195, 64, v42
    v_xor_b32 v192, 128, v41
    v_xor_b32 v196, 128, v42
    v_xor_b32 v193, 192, v41
    v_xor_b32 v197, 192, v42
    s_cmp_ge_u32 s73, 16
    s_cbranch_scc1 L_sk_8
    v_mov_b32 v5, 0
    s_mov_b64 exec, 1
    s_mov_b32 s82, 0
L_poll_9:
    buffer_load_dword v251, v5, s[56:59], 0 offen sc1
    s_add_u32 s82, s82, 1
    s_cmp_gt_u32 s82, 0x40000
    s_cbranch_scc1 L_end
    s_waitcnt vmcnt(0)
    v_cmp_gt_u32 vcc, 16, v251
    s_cbranch_vccz L_pok_10
    s_sleep 2
    s_branch L_poll_9
L_pok_10:
    s_mov_b64 exec, -1
L_sk_8:
    s_waitcnt vmcnt(4) lgkmcnt(2)
    s_barrier
    ds_read_b128 v[144:147], v190
    ds_read_b128 v[160:163], v190 offset:256
    ds_read_b128 v[148:151], v191
    ds_read_b128 v[164:167], v191 offset:256
    ds_read_b128 v[152:155], v192
    ds_read_b128 v[168:171], v192 offset:256
    ds_read_b128 v[156:159], v193
    ds_read_b128 v[172:175], v193 offset:256
    v_mfma_f32_16x16x32_bf16 v[108:111], v[60:63], a[0:3], 0
    ds_read_b32 v176, v194
    v_mfma_f32_16x16x32_bf16 v[112:115], v[60:63], a[4:7], 0
    ds_read_b32 v180, v194 offset:256
    v_mfma_f32_16x16x32_bf16 v[116:119], v[60:63], a[8:11], 0
    ds_read_b32 v177, v195
    v_mfma_f32_16x16x32_bf16 v[120:123], v[60:63], a[12:15], 0
    ds_read_b32 v181, v195 offset:256
    v_mfma_f32_16x16x32_bf16 v[132:135], v[60:63], v[24:27], 0
    s_waitcnt lgkmcnt(12)
    ds_read_b64_tr_b16 v[60:61], v185 offset:2048
    v_mfma_f32_16x16x32_bf16 v[108:111], v[68:71], a[16:19], v[108:111]
    ds_read_b64_tr_b16 v[62:63], v185 offset:2560
    v_mfma_f32_16x16x32_bf16 v[112:115], v[68:71], a[20:23], v[112:115]
    ds_read_b32 v178, v196
    v_mfma_f32_16x16x32_bf16 v[116:119], v[68:71], a[24:27], v[116:119]
    ds_read_b32 v182, v196 offset:256
    v_mfma_f32_16x16x32_bf16 v[120:123], v[68:71], a[28:31], v[120:123]
    v_mfma_f32_16x16x32_bf16 v[132:135], v[68:71], v[24:27], v[132:135]
    s_waitcnt lgkmcnt(2)
    ds_read_b64_tr_b16 v[68:69], v185 offset:3072
    v_mfma_f32_16x16x32_bf16 v[108:111], v[60:63], a[32:35], v[108:111]
    ds_read_b64_tr_b16 v[70:71], v185 offset:3584
    v_mfma_f32_16x16x32_bf16 v[112:115], v[60:63], a[36:39], v[112:115]
    ds_read_b32 v179, v197
    v_mfma_f32_16x16x32_bf16 v[116:119], v[60:63], a[40:43], v[116:119]
    ds_read_b32 v183, v197 offset:256
    v_mfma_f32_16x16x32_bf16 v[120:123], v[60:63], a[44:47], v[120:123]
    v_mfma_f32_16x16x32_bf16 v[132:135], v[60:63], v[24:27], v[132:135]
    s_waitcnt lgkmcnt(2)
    ds_read_b64_tr_b16 v[60:61], v185 offset:16384
    v_mfma_f32_16x16x32_bf16 v[108:111], v[68:71], a[48:51], v[108:111]
    ds_read_b64_tr_b16 v[62:63], v185 offset:16896
    v_mfma_f32_16x16x32_bf16 v[112:115], v[68:71], a[52:55], v[112:115]
    v_mfma_f32_16x16x32_bf16 v[116:119], v[68:71], a[56:59], v[116:119]
    v_mfma_f32_16x16x32_bf16 v[120:123], v[68:71], a[60:63], v[120:123]
    v_mfma_f32_16x16x32_bf16 v[132:135], v[68:71], v[24:27], v[132:135]
    ds_read_b64_tr_b16 v[68:69], v185 offset:17408
    ds_read_b64_tr_b16 v[70:71], v185 offset:17920
    s_mul_i32 s86, s78, 1152
    v_pk_fma_f32 v[76:77], v[144:145], v[124:125], v[76:77] op_sel:[0,0,0] op_sel_hi:[1,0,1] neg_lo:[1,0,0] neg_hi:[1,0,0]
    v_pk_fma_f32 v[78:79], v[146:147], v[124:125], v[78:79] op_sel:[0,0,0] op_sel_hi:[1,0,1] neg_lo:[1,0,0] neg_hi:[1,0,0]
    v_pk_fma_f32 v[80:81], v[148:149], v[124:125], v[80:81] op_sel:[0,0,0] op_sel_hi:[1,0,1] neg_lo:[1,0,0] neg_hi:[1,0,0]
    v_pk_fma_f32 v[82:83], v[150:151], v[124:125], v[82:83] op_sel:[0,0,0] op_sel_hi:[1,0,1] neg_lo:[1,0,0] neg_hi:[1,0,0]
    v_pk_fma_f32 v[76:77], v[76:77], v[160:161], s[96:97] op_sel:[0,0,0] op_sel_hi:[1,1,1]
    v_pk_fma_f32 v[78:79], v[78:79], v[162:163], s[96:97] op_sel:[0,0,0] op_sel_hi:[1,1,1]
    v_pk_fma_f32 v[80:81], v[80:81], v[164:165], s[96:97] op_sel:[0,0,0] op_sel_hi:[1,1,1]
    v_pk_fma_f32 v[82:83], v[82:83], v[166:167], s[96:97] op_sel:[0,0,0] op_sel_hi:[1,1,1]
    v_pk_mul_f32 v[190:191], v[76:77], s[98:99]
    v_pk_mul_f32 v[192:193], v[78:79], s[98:99]
    v_pk_mul_f32 v[194:195], v[80:81], s[98:99]
    v_pk_mul_f32 v[196:197], v[82:83], s[98:99]
    v_max_f32 v76, s96, v76
    v_max_f32 v78, s96, v78
    v_max_f32 v80, s96, v80
    v_max_f32 v82, s96, v82
    v_exp_f32_e64 v190, v190 clamp
    v_exp_f32_e64 v192, v192 clamp
    v_exp_f32_e64 v194, v194 clamp
    v_exp_f32_e64 v196, v196 clamp
    v_max_f32 v77, s96, v77
    v_max_f32 v79, s96, v79
    v_max_f32 v81, s96, v81
    v_max_f32 v83, s96, v83
    v_exp_f32_e64 v191, v191 clamp
    v_exp_f32_e64 v193, v193 clamp
    v_exp_f32_e64 v195, v195 clamp
    v_exp_f32_e64 v197, v197 clamp
    v_pk_add_f32 v[76:77], v[76:77], v[190:191]
    v_pk_add_f32 v[78:79], v[78:79], v[192:193]
    v_pk_add_f32 v[80:81], v[80:81], v[194:195]
    v_pk_add_f32 v[82:83], v[82:83], v[196:197]
    v_pk_fma_f32 v[92:93], v[144:145], v[128:129], v[92:93] op_sel_hi:[1,0,1] neg_lo:[1,0,0] neg_hi:[1,0,0]
    v_pk_fma_f32 v[94:95], v[146:147], v[128:129], v[94:95] op_sel_hi:[1,0,1] neg_lo:[1,0,0] neg_hi:[1,0,0]
    v_pk_fma_f32 v[96:97], v[148:149], v[128:129], v[96:97] op_sel_hi:[1,0,1] neg_lo:[1,0,0] neg_hi:[1,0,0]
    v_pk_fma_f32 v[98:99], v[150:151], v[128:129], v[98:99] op_sel_hi:[1,0,1] neg_lo:[1,0,0] neg_hi:[1,0,0]
    v_pk_mul_f32 v[92:93], v[92:93], v[160:161]
    v_pk_mul_f32 v[94:95], v[94:95], v[162:163]
    v_pk_mul_f32 v[96:97], v[96:97], v[164:165]
    v_pk_mul_f32 v[98:99], v[98:99], v[166:167]
    v_cvt_pk_bf16_f32 v208, v76, v77
    v_cvt_pk_bf16_f32 v216, v92, v93
    v_cvt_pk_bf16_f32 v209, v78, v79
    v_cvt_pk_bf16_f32 v217, v94, v95
    v_cvt_pk_bf16_f32 v210, v80, v81
    v_cvt_pk_bf16_f32 v218, v96, v97
    v_cvt_pk_bf16_f32 v211, v82, v83
    v_cvt_pk_bf16_f32 v219, v98, v99
    v_pk_fma_f32 v[84:85], v[152:153], v[124:125], v[84:85] op_sel:[0,0,0] op_sel_hi:[1,0,1] neg_lo:[1,0,0] neg_hi:[1,0,0]
    v_pk_fma_f32 v[86:87], v[154:155], v[124:125], v[86:87] op_sel:[0,0,0] op_sel_hi:[1,0,1] neg_lo:[1,0,0] neg_hi:[1,0,0]
    v_pk_fma_f32 v[88:89], v[156:157], v[124:125], v[88:89] op_sel:[0,0,0] op_sel_hi:[1,0,1] neg_lo:[1,0,0] neg_hi:[1,0,0]
    v_pk_fma_f32 v[90:91], v[158:159], v[124:125], v[90:91] op_sel:[0,0,0] op_sel_hi:[1,0,1] neg_lo:[1,0,0] neg_hi:[1,0,0]
    v_pk_fma_f32 v[84:85], v[84:85], v[168:169], s[96:97] op_sel:[0,0,0] op_sel_hi:[1,1,1]
    v_pk_fma_f32 v[86:87], v[86:87], v[170:171], s[96:97] op_sel:[0,0,0] op_sel_hi:[1,1,1]
    v_pk_fma_f32 v[88:89], v[88:89], v[172:173], s[96:97] op_sel:[0,0,0] op_sel_hi:[1,1,1]
    v_pk_fma_f32 v[90:91], v[90:91], v[174:175], s[96:97] op_sel:[0,0,0] op_sel_hi:[1,1,1]
    v_pk_mul_f32 v[190:191], v[84:85], s[98:99]
    v_pk_mul_f32 v[192:193], v[86:87], s[98:99]
    v_pk_mul_f32 v[194:195], v[88:89], s[98:99]
    v_pk_mul_f32 v[196:197], v[90:91], s[98:99]
    v_max_f32 v84, s96, v84
    v_max_f32 v86, s96, v86
    v_max_f32 v88, s96, v88
    v_max_f32 v90, s96, v90
    v_exp_f32_e64 v190, v190 clamp
    v_exp_f32_e64 v192, v192 clamp
    v_exp_f32_e64 v194, v194 clamp
    v_exp_f32_e64 v196, v196 clamp
    v_max_f32 v85, s96, v85
    v_max_f32 v87, s96, v87
    v_max_f32 v89, s96, v89
    v_max_f32 v91, s96, v91
    v_exp_f32_e64 v191, v191 clamp
    v_exp_f32_e64 v193, v193 clamp
    v_exp_f32_e64 v195, v195 clamp
    v_exp_f32_e64 v197, v197 clamp
    v_pk_add_f32 v[84:85], v[84:85], v[190:191]
    v_pk_add_f32 v[86:87], v[86:87], v[192:193]
    v_pk_add_f32 v[88:89], v[88:89], v[194:195]
    v_pk_add_f32 v[90:91], v[90:91], v[196:197]
    v_pk_fma_f32 v[100:101], v[152:153], v[128:129], v[100:101] op_sel_hi:[1,0,1] neg_lo:[1,0,0] neg_hi:[1,0,0]
    v_pk_fma_f32 v[102:103], v[154:155], v[128:129], v[102:103] op_sel_hi:[1,0,1] neg_lo:[1,0,0] neg_hi:[1,0,0]
    v_pk_fma_f32 v[104:105], v[156:157], v[128:129], v[104:105] op_sel_hi:[1,0,1] neg_lo:[1,0,0] neg_hi:[1,0,0]
    v_pk_fma_f32 v[106:107], v[158:159], v[128:129], v[106:107] op_sel_hi:[1,0,1] neg_lo:[1,0,0] neg_hi:[1,0,0]
    v_pk_mul_f32 v[100:101], v[100:101], v[168:169]
    v_pk_mul_f32 v[102:103], v[102:103], v[170:171]
    v_pk_mul_f32 v[104:105], v[104:105], v[172:173]
    v_pk_mul_f32 v[106:107], v[106:107], v[174:175]
    v_cvt_pk_bf16_f32 v212, v84, v85
    v_cvt_pk_bf16_f32 v220, v100, v101
    v_cvt_pk_bf16_f32 v213, v86, v87
    v_cvt_pk_bf16_f32 v221, v102, v103
    v_cvt_pk_bf16_f32 v214, v88, v89
    v_cvt_pk_bf16_f32 v222, v104, v105
    v_cvt_pk_bf16_f32 v215, v90, v91
    v_cvt_pk_bf16_f32 v223, v106, v107
    v_mfma_f32_16x16x32_bf16 v[224:227], v[216:219], v[208:211], 0
    v_mfma_f32_16x16x32_bf16 v[228:231], v[24:27], v[208:211], 0
    v_mfma_f32_16x16x32_bf16 v[224:227], v[220:223], v[212:215], v[224:227]
    v_mfma_f32_16x16x32_bf16 v[228:231], v[24:27], v[212:215], v[228:231]
    s_waitcnt lgkmcnt(2)
    v_mfma_f32_16x16x32_bf16 v[108:111], v[60:63], a[64:67], v[108:111]
    v_mfma_f32_16x16x32_bf16 v[112:115], v[60:63], a[68:71], v[112:115]
    v_mfma_f32_16x16x32_bf16 v[116:119], v[60:63], a[72:75], v[116:119]
    v_mfma_f32_16x16x32_bf16 v[120:123], v[60:63], a[76:79], v[120:123]
    s_nop 1
    buffer_atomic_add_f32 v224, v43, s[32:35], s86 offen offset:0
    v_mfma_f32_16x16x32_bf16 v[132:135], v[60:63], v[24:27], v[132:135]
    s_waitcnt lgkmcnt(0)
    ds_read_b64_tr_b16 v[60:61], v185 offset:18432
    v_mfma_f32_16x16x32_bf16 v[108:111], v[68:71], a[80:83], v[108:111]
    ds_read_b64_tr_b16 v[62:63], v185 offset:18944
    v_mfma_f32_16x16x32_bf16 v[112:115], v[68:71], a[84:87], v[112:115]
    buffer_atomic_add_f32 v225, v43, s[32:35], s86 offen offset:64
    v_mfma_f32_16x16x32_bf16 v[116:119], v[68:71], a[88:91], v[116:119]
    buffer_atomic_add_f32 v226, v43, s[32:35], s86 offen offset:128
    v_mfma_f32_16x16x32_bf16 v[120:123], v[68:71], a[92:95], v[120:123]
    buffer_atomic_add_f32 v227, v43, s[32:35], s86 offen offset:192
    v_mfma_f32_16x16x32_bf16 v[132:135], v[68:71], v[24:27], v[132:135]
    s_waitcnt lgkmcnt(0)
    ds_read_b64_tr_b16 v[68:69], v185 offset:19456
    v_mfma_f32_16x16x32_bf16 v[108:111], v[60:63], a[96:99], v[108:111]
    ds_read_b64_tr_b16 v[70:71], v185 offset:19968
    v_mfma_f32_16x16x32_bf16 v[112:115], v[60:63], a[100:103], v[112:115]
    s_mov_b32 exec_lo, 0xffff
    s_mov_b32 exec_hi, 0x0
    buffer_atomic_add_f32 v228, v22, s[32:35], s86 offen offset:1024
    s_mov_b64 exec, -1
    v_mfma_f32_16x16x32_bf16 v[116:119], v[60:63], a[104:107], v[116:119]
    s_add_u32 s74, s3, 0
    v_mfma_f32_16x16x32_bf16 v[120:123], v[60:63], a[108:111], v[120:123]
    s_and_b32 s74, s74, 3
    v_mfma_f32_16x16x32_bf16 v[132:135], v[60:63], v[24:27], v[132:135]
    s_waitcnt lgkmcnt(0)
    ds_read_b64_tr_b16 v[60:61], v20 offset:0
    v_mfma_f32_16x16x32_bf16 v[108:111], v[68:71], a[112:115], v[108:111]
    s_lshl2_add_u32 s74, s60, s74
    ds_read_b64_tr_b16 v[62:63], v20 offset:512
    v_mfma_f32_16x16x32_bf16 v[112:115], v[68:71], a[116:119], v[112:115]
    s_lshl_b32 s85, s74, 12
    v_mfma_f32_16x16x32_bf16 v[116:119], v[68:71], a[120:123], v[116:119]
    s_add_u32 m0, s85, s9
    v_mfma_f32_16x16x32_bf16 v[120:123], v[68:71], a[124:127], v[120:123]
    s_lshl_b32 s74, s74, 15
    v_mfma_f32_16x16x32_bf16 v[132:135], v[68:71], v[24:27], v[132:135]
    s_waitcnt lgkmcnt(0)
    ds_read_b64_tr_b16 v[68:69], v20 offset:1024
    v_mfma_f32_16x16x32_bf16 v[108:111], v[60:63], a[128:131], v[108:111]
    s_lshl_b32 s75, s67, 7
    ds_read_b64_tr_b16 v[70:71], v20 offset:1536
    s_add_u32 s84, s74, s75
    v_mfma_f32_16x16x32_bf16 v[112:115], v[60:63], a[132:135], v[112:115]
    buffer_load_dwordx4 v28, s[36:39], s84 offen offset:0 lds
    v_mfma_f32_16x16x32_bf16 v[116:119], v[60:63], a[136:139], v[116:119]
    v_mfma_f32_16x16x32_bf16 v[120:123], v[60:63], a[140:143], v[120:123]
    buffer_load_dwordx4 v29, s[36:39], s84 offen offset:1024 lds
    v_mfma_f32_16x16x32_bf16 v[132:135], v[60:63], v[24:27], v[132:135]
    s_waitcnt lgkmcnt(0)
    ds_read_b64_tr_b16 v[60:61], v20 offset:2048
    v_mfma_f32_16x16x32_bf16 v[108:111], v[68:71], a[144:147], v[108:111]
    ds_read_b64_tr_b16 v[62:63], v20 offset:2560
    v_mfma_f32_16x16x32_bf16 v[112:115], v[68:71], a[148:151], v[112:115]
    buffer_load_dwordx4 v30, s[36:39], s84 offen offset:2048 lds
    v_mfma_f32_16x16x32_bf16 v[116:119], v[68:71], a[152:155], v[116:119]
    v_mfma_f32_16x16x32_bf16 v[120:123], v[68:71], a[156:159], v[120:123]
    v_mfma_f32_16x16x32_bf16 v[132:135], v[68:71], v[24:27], v[132:135]
    s_waitcnt lgkmcnt(0)
    ds_read_b64_tr_b16 v[68:69], v20 offset:3072
    v_mfma_f32_16x16x32_bf16 v[108:111], v[60:63], a[160:163], v[108:111]
    ds_read_b64_tr_b16 v[70:71], v20 offset:3584
    v_mfma_f32_16x16x32_bf16 v[112:115], v[60:63], a[164:167], v[112:115]
    buffer_load_dwordx4 v31, s[36:39], s84 offen offset:3072 lds
    v_mfma_f32_16x16x32_bf16 v[116:119], v[60:63], a[168:171], v[116:119]
    v_mfma_f32_16x16x32_bf16 v[120:123], v[60:63], a[172:175], v[120:123]
    v_mfma_f32_16x16x32_bf16 v[132:135], v[60:63], v[24:27], v[132:135]
    s_waitcnt lgkmcnt(0)
    ds_read_b64_tr_b16 v[60:61], v20 offset:16384
    v_mfma_f32_16x16x32_bf16 v[108:111], v[68:71], a[176:179], v[108:111]
    ds_read_b64_tr_b16 v[62:63], v20 offset:16896
    v_mfma_f32_16x16x32_bf16 v[112:115], v[68:71], a[180:183], v[112:115]
    v_mfma_f32_16x16x32_bf16 v[116:119], v[68:71], a[184:187], v[116:119]
    v_mfma_f32_16x16x32_bf16 v[120:123], v[68:71], a[188:191], v[120:123]
    v_mfma_f32_16x16x32_bf16 v[132:135], v[68:71], v[24:27], v[132:135]
    s_waitcnt lgkmcnt(0)
    ds_read_b64_tr_b16 v[68:69], v20 offset:17408
    v_mfma_f32_16x16x32_bf16 v[108:111], v[60:63], a[192:195], v[108:111]
    ds_read_b64_tr_b16 v[70:71], v20 offset:17920
    v_mfma_f32_16x16x32_bf16 v[112:115], v[60:63], a[196:199], v[112:115]
    v_mfma_f32_16x16x32_bf16 v[116:119], v[60:63], a[200:203], v[116:119]
    v_mfma_f32_16x16x32_bf16 v[120:123], v[60:63], a[204:207], v[120:123]
    v_mfma_f32_16x16x32_bf16 v[132:135], v[60:63], v[24:27], v[132:135]
    s_waitcnt lgkmcnt(0)
    ds_read_b64_tr_b16 v[60:61], v20 offset:18432
    v_mfma_f32_16x16x32_bf16 v[108:111], v[68:71], a[208:211], v[108:111]
    ds_read_b64_tr_b16 v[62:63], v20 offset:18944
    v_mfma_f32_16x16x32_bf16 v[112:115], v[68:71], a[212:215], v[112:115]
    v_mfma_f32_16x16x32_bf16 v[116:119], v[68:71], a[216:219], v[116:119]
    v_mfma_f32_16x16x32_bf16 v[120:123], v[68:71], a[220:223], v[120:123]
    v_mfma_f32_16x16x32_bf16 v[132:135], v[68:71], v[24:27], v[132:135]
    s_waitcnt lgkmcnt(0)
    ds_read_b64_tr_b16 v[68:69], v20 offset:19456
    v_mfma_f32_16x16x32_bf16 v[108:111], v[60:63], a[224:227], v[108:111]
    ds_read_b64_tr_b16 v[70:71], v20 offset:19968
    v_mfma_f32_16x16x32_bf16 v[112:115], v[60:63], a[228:231], v[112:115]
    v_mfma_f32_16x16x32_bf16 v[116:119], v[60:63], a[232:235], v[116:119]
    v_mfma_f32_16x16x32_bf16 v[120:123], v[60:63], a[236:239], v[120:123]
    v_mfma_f32_16x16x32_bf16 v[132:135], v[60:63], v[24:27], v[132:135]
    s_waitcnt lgkmcnt(0)
    v_mfma_f32_16x16x32_bf16 v[108:111], v[68:71], a[240:243], v[108:111]
    v_mfma_f32_16x16x32_bf16 v[112:115], v[68:71], a[244:247], v[112:115]
    v_mfma_f32_16x16x32_bf16 v[116:119], v[68:71], a[248:251], v[116:119]
    v_mfma_f32_16x16x32_bf16 v[120:123], v[68:71], a[252:255], v[120:123]
    v_mfma_f32_16x16x32_bf16 v[132:135], v[68:71], v[24:27], v[132:135]
    s_lshr_b32 s72, s60, 1
    s_lshl1_add_u32 s72, s63, s72
    s_lshl_b32 s72, s72, 5
    s_add_u32 s72, s72, s78
    s_lshl_b32 s72, s72, 10
    s_add_u32 s72, s72, 1048576
    s_xor_b32 s73, s72, 32768
    s_nop 0
    v_pk_fma_f32 v[108:109], v[176:177], v[132:133], v[108:109] op_sel:[0,0,0] op_sel_hi:[0,1,1] neg_lo:[1,0,0] neg_hi:[1,0,0]
    v_pk_fma_f32 v[110:111], v[176:177], v[134:135], v[110:111] op_sel:[0,0,0] op_sel_hi:[0,1,1] neg_lo:[1,0,0] neg_hi:[1,0,0]
    v_pk_fma_f32 v[112:113], v[176:177], v[132:133], v[112:113] op_sel:[1,0,0] op_sel_hi:[1,1,1] neg_lo:[1,0,0] neg_hi:[1,0,0]
    v_pk_fma_f32 v[114:115], v[176:177], v[134:135], v[114:115] op_sel:[1,0,0] op_sel_hi:[1,1,1] neg_lo:[1,0,0] neg_hi:[1,0,0]
    v_pk_fma_f32 v[108:109], v[108:109], v[180:181], s[96:97] op_sel:[0,0,0] op_sel_hi:[1,0,1]
    v_pk_fma_f32 v[110:111], v[110:111], v[180:181], s[96:97] op_sel:[0,0,0] op_sel_hi:[1,0,1]
    v_pk_fma_f32 v[112:113], v[112:113], v[180:181], s[96:97] op_sel:[0,1,0] op_sel_hi:[1,1,1]
    v_pk_fma_f32 v[114:115], v[114:115], v[180:181], s[96:97] op_sel:[0,1,0] op_sel_hi:[1,1,1]
    v_pk_mul_f32 v[144:145], v[108:109], s[98:99]
    v_pk_mul_f32 v[146:147], v[110:111], s[98:99]
    v_pk_mul_f32 v[148:149], v[112:113], s[98:99]
    v_pk_mul_f32 v[150:151], v[114:115], s[98:99]
    v_max_f32 v108, s96, v108
    v_max_f32 v110, s96, v110
    v_max_f32 v112, s96, v112
    v_max_f32 v114, s96, v114
    v_exp_f32_e64 v144, v144 clamp
    v_exp_f32_e64 v146, v146 clamp
    v_exp_f32_e64 v148, v148 clamp
    v_exp_f32_e64 v150, v150 clamp
    v_max_f32 v109, s96, v109
    v_max_f32 v111, s96, v111
    v_max_f32 v113, s96, v113
    v_max_f32 v115, s96, v115
    v_exp_f32_e64 v145, v145 clamp
    v_exp_f32_e64 v147, v147 clamp
    v_exp_f32_e64 v149, v149 clamp
    v_exp_f32_e64 v151, v151 clamp
    v_pk_add_f32 v[108:109], v[108:109], v[144:145]
    v_pk_add_f32 v[110:111], v[110:111], v[146:147]
    v_pk_add_f32 v[112:113], v[112:113], v[148:149]
    v_pk_add_f32 v[114:115], v[114:115], v[150:151]
    v_cvt_pk_bf16_f32 v208, v108, v109
    v_cvt_pk_bf16_f32 v209, v110, v111
    v_cvt_pk_bf16_f32 v210, v112, v113
    v_cvt_pk_bf16_f32 v211, v114, v115
    s_nop 0
    v_permlane16_swap_b32 v208, v210
    v_permlane16_swap_b32 v209, v211
    buffer_store_dwordx4 v[208:211], v248, s[32:35], s72 offen sc1
    v_pk_fma_f32 v[116:117], v[178:179], v[132:133], v[116:117] op_sel:[0,0,0] op_sel_hi:[0,1,1] neg_lo:[1,0,0] neg_hi:[1,0,0]
    v_pk_fma_f32 v[118:119], v[178:179], v[134:135], v[118:119] op_sel:[0,0,0] op_sel_hi:[0,1,1] neg_lo:[1,0,0] neg_hi:[1,0,0]
    v_pk_fma_f32 v[120:121], v[178:179], v[132:133], v[120:121] op_sel:[1,0,0] op_sel_hi:[1,1,1] neg_lo:[1,0,0] neg_hi:[1,0,0]
    v_pk_fma_f32 v[122:123], v[178:179], v[134:135], v[122:123] op_sel:[1,0,0] op_sel_hi:[1,1,1] neg_lo:[1,0,0] neg_hi:[1,0,0]
    v_pk_fma_f32 v[116:117], v[116:117], v[182:183], s[96:97] op_sel:[0,0,0] op_sel_hi:[1,0,1]
    v_pk_fma_f32 v[118:119], v[118:119], v[182:183], s[96:97] op_sel:[0,0,0] op_sel_hi:[1,0,1]
    v_pk_fma_f32 v[120:121], v[120:121], v[182:183], s[96:97] op_sel:[0,1,0] op_sel_hi:[1,1,1]
    v_pk_fma_f32 v[122:123], v[122:123], v[182:183], s[96:97] op_sel:[0,1,0] op_sel_hi:[1,1,1]
    v_pk_mul_f32 v[144:145], v[116:117], s[98:99]
    v_pk_mul_f32 v[146:147], v[118:119], s[98:99]
    v_pk_mul_f32 v[148:149], v[120:121], s[98:99]
    v_pk_mul_f32 v[150:151], v[122:123], s[98:99]
    v_max_f32 v116, s96, v116
    v_max_f32 v118, s96, v118
    v_max_f32 v120, s96, v120
    v_max_f32 v122, s96, v122
    v_exp_f32_e64 v144, v144 clamp
    v_exp_f32_e64 v146, v146 clamp
    v_exp_f32_e64 v148, v148 clamp
    v_exp_f32_e64 v150, v150 clamp
    v_max_f32 v117, s96, v117
    v_max_f32 v119, s96, v119
    v_max_f32 v121, s96, v121
    v_max_f32 v123, s96, v123
    v_exp_f32_e64 v145, v145 clamp
    v_exp_f32_e64 v147, v147 clamp
    v_exp_f32_e64 v149, v149 clamp
    v_exp_f32_e64 v151, v151 clamp
    v_pk_add_f32 v[116:117], v[116:117], v[144:145]
    v_pk_add_f32 v[118:119], v[118:119], v[146:147]
    v_pk_add_f32 v[120:121], v[120:121], v[148:149]
    v_pk_add_f32 v[122:123], v[122:123], v[150:151]
    v_cvt_pk_bf16_f32 v212, v116, v117
    v_cvt_pk_bf16_f32 v213, v118, v119
    v_cvt_pk_bf16_f32 v214, v120, v121
    v_cvt_pk_bf16_f32 v215, v122, v123
    s_nop 0
    v_permlane16_swap_b32 v212, v214
    v_permlane16_swap_b32 v213, v215
    buffer_store_dwordx4 v[212:215], v248, s[32:35], s73 offen sc1
    s_add_u32 s74, s3, 1
    s_and_b32 s74, s74, 3
    s_lshl2_add_u32 s74, s60, s74
    s_lshl_b32 s85, s74, 12
    s_add_u32 m0, s85, s9
    s_lshl_b32 s74, s74, 15
    s_lshl_b32 s75, s67, 7
    s_add_u32 s84, s74, s75
    buffer_load_dwordx4 v28, s[36:39], s84 offen offset:0 lds
    buffer_load_dwordx4 v29, s[36:39], s84 offen offset:1024 lds
    buffer_load_dwordx4 v30, s[36:39], s84 offen offset:2048 lds
    buffer_load_dwordx4 v31, s[36:39], s84 offen offset:3072 lds
    s_add_u32 s74, s3, 2
    s_and_b32 s74, s74, 3
    s_lshl2_add_u32 s74, s60, s74
    s_lshl_b32 s85, s74, 12
    s_add_u32 m0, s85, s9
    s_lshl_b32 s74, s74, 15
    s_lshl_b32 s75, s67, 7
    s_add_u32 s84, s74, s75
    buffer_load_dwordx4 v28, s[36:39], s84 offen offset:0 lds
    buffer_load_dwordx4 v29, s[36:39], s84 offen offset:1024 lds
    s_add_u32 s75, s3, s67
    s_add_u32 s72, s75, 0
    s_and_b32 s72, s72, 3
    s_lshl2_add_u32 s72, s60, s72
    s_lshl_b32 s74, 1, s72
    s_sub_u32 s74, s74, 1
    s_and_b32 s74, s74, 0x1133
    s_bcnt1_i32_b32 s74, s74
    s_mul_i32 s72, s72, 5
    s_add_u32 s72, s72, s74
    s_lshl_b32 s4, s72, 10
    s_add_u32 s72, s75, 1
    s_and_b32 s72, s72, 3
    s_lshl2_add_u32 s72, s60, s72
    s_lshl_b32 s74, 1, s72
    s_sub_u32 s74, s74, 1
    s_and_b32 s74, s74, 0x1133
    s_bcnt1_i32_b32 s74, s74
    s_mul_i32 s72, s72, 5
    s_add_u32 s72, s72, s74
    s_lshl_b32 s5, s72, 10
    s_add_u32 s72, s75, 2
    s_and_b32 s72, s72, 3
    s_lshl2_add_u32 s72, s60, s72
    s_lshl_b32 s74, 1, s72
    s_sub_u32 s74, s74, 1
    s_and_b32 s74, s74, 0x1133
    s_bcnt1_i32_b32 s74, s74
    s_mul_i32 s72, s72, 5
    s_add_u32 s72, s72, s74
    s_lshl_b32 s6, s72, 10
    s_add_u32 s72, s75, 3
    s_and_b32 s72, s72, 3
    s_lshl2_add_u32 s72, s60, s72
    s_lshl_b32 s74, 1, s72
    s_sub_u32 s74, s74, 1
    s_and_b32 s74, s74, 0x1133
    s_bcnt1_i32_b32 s74, s74
    s_mul_i32 s72, s72, 5
    s_add_u32 s72, s72, s74
    s_lshl_b32 s7, s72, 10
    s_lshl2_add_u32 s72, s60, 0
    s_lshl_b32 s74, 1, s72
    s_sub_u32 s74, s74, 1
    s_and_b32 s74, s74, 0x1133
    s_bcnt1_i32_b32 s74, s74
    s_mul_i32 s72, s72, 5
    s_add_u32 s72, s72, s74
    s_lshl_b32 s10, s72, 10
    s_lshl2_add_u32 s72, s60, 1
    s_lshl_b32 s74, 1, s72
    s_sub_u32 s74, s74, 1
    s_and_b32 s74, s74, 0x1133
    s_bcnt1_i32_b32 s74, s74
    s_mul_i32 s72, s72, 5
    s_add_u32 s72, s72, s74
    s_lshl_b32 s11, s72, 10
    v_mov_b32 v4, 0
    v_mov_b32 v5, 0
    v_mov_b32 v6, 0
    v_mov_b32 v7, 0
    v_mov_b32 v8, 0
    v_mov_b32 v9, 0
    v_mov_b32 v10, 0
    v_mov_b32 v11, 0
    v_mov_b32 v12, s96
    v_mov_b32 v13, s96
    v_mov_b32 v14, s96
    v_mov_b32 v15, s96
    v_mov_b32 v16, s96
    v_mov_b32 v17, s96
    v_mov_b32 v18, s96
    v_mov_b32 v19, s96
    s_lshl1_add_u32 s72, s60, s67
    s_add_u32 s72, s72, 0
    s_and_b32 s72, s72, 7
    s_lshl_b32 s72, s72, 12
    v_add_u32 v248, s72, v21
    s_lshl1_add_u32 s72, s60, s67
    s_add_u32 s72, s72, 1
    s_and_b32 s72, s72, 7
    s_lshl_b32 s72, s72, 12
    v_add_u32 v251, s72, v21
    v_lshrrev_b32 v2, 5, v1
    v_and_b32 v3, 31, v1
    v_lshlrev_b32 v3, 2, v3
    v_lshl_add_u32 v252, v2, 10, v3
    s_lshl_b32 s72, s60, 13
    s_add_u32 s72, s72, 65536
    v_add_u32 v245, s72, v245
    s_mov_b32 s21, 36864
    s_waitcnt vmcnt(6)
    s_barrier
    s_cmp_lg_u32 s60, 0
    s_cbranch_scc1 L_sk_11
    s_mov_b32 exec_lo, 0x1ff
    s_mov_b32 exec_hi, 0x0
    buffer_atomic_add v23, v241, s[32:35], s21 offen sc1
    s_mov_b64 exec, -1
L_sk_11:
    s_add_u32 m0, s85, s9
    s_nop 0
    buffer_load_dwordx4 v30, s[36:39], s84 offen offset:2048 lds
    buffer_load_dwordx4 v31, s[36:39], s84 offen offset:3072 lds
    s_add_u32 s74, s3, 3
    s_and_b32 s74, s74, 3
    s_lshl2_add_u32 s74, s60, s74
    s_lshl_b32 s85, s74, 12
    s_add_u32 m0, s85, s9
    s_lshl_b32 s74, s74, 15
    s_lshl_b32 s75, s67, 7
    s_add_u32 s84, s74, s75
    buffer_load_dwordx4 v28, s[36:39], s84 offen offset:0 lds
    buffer_load_dwordx4 v29, s[36:39], s84 offen offset:1024 lds
    buffer_load_dwordx4 v30, s[36:39], s84 offen offset:2048 lds
    buffer_load_dwordx4 v31, s[36:39], s84 offen offset:3072 lds
    ds_read_b64_tr_b16 v[44:45], v36
    ds_read_b64_tr_b16 v[46:47], v36 offset:512
    ds_read_b64_tr_b16 v[48:49], v37
    ds_read_b64_tr_b16 v[50:51], v37 offset:512
    ds_read_b64_tr_b16 v[52:53], v38
    ds_read_b64_tr_b16 v[54:55], v38 offset:512
    ds_read_b64_tr_b16 v[56:57], v39
    ds_read_b64_tr_b16 v[58:59], v39 offset:512
    s_cmp_eq_u32 s94, 0
    s_cbranch_scc1 L_sk_12
    ds_read_b64_tr_b16 v[184:185], v40
    ds_read_b64_tr_b16 v[186:187], v40 offset:512
    s_waitcnt lgkmcnt(0)
    buffer_store_dwordx4 v[184:187], v21, s[32:35], s94 offen sc1
L_sk_12:
    s_waitcnt lgkmcnt(0)
    s_cmp_eq_u32 s91, 0
    s_cbranch_scc1 L_sk_13
    buffer_store_dwordx4 v[44:47], v21, s[32:35], s91 offen offset:0 sc1
    buffer_store_dwordx4 v[48:51], v21, s[32:35], s91 offen offset:1024 sc1
    buffer_store_dwordx4 v[52:55], v21, s[32:35], s91 offen offset:2048 sc1
    buffer_store_dwordx4 v[56:59], v21, s[32:35], s91 offen offset:3072 sc1
L_sk_13:
    s_cmp_eq_u32 s92, 0
    s_cbranch_scc1 L_sk_14
    v_mfma_f32_32x32x16_bf16 v[190:205], v[24:27], v[44:47], 0
    v_mfma_f32_32x32x16_bf16 v[190:205], v[24:27], v[48:51], v[190:205]
    v_mfma_f32_32x32x16_bf16 v[190:205], v[24:27], v[52:55], v[190:205]
    v_mfma_f32_32x32x16_bf16 v[190:205], v[24:27], v[56:59], v[190:205]
    s_mov_b32 exec_lo, 0xffffffff
    s_mov_b32 exec_hi, 0x0
    s_nop 9
    buffer_store_dword v190, v22, s[32:35], s92 offen sc1
    s_mov_b64 exec, -1
L_sk_14:
    buffer_load_dwordx4 v[232:235], v240, s[24:27], s83 offen
    buffer_load_dwordx4 v[236:239], v240, s[24:27], s83 offen offset:16
    s_waitcnt vmcnt(2)
    ds_read_b64_tr_b16 a[0:1], v32 offset:0
    ds_read_b64_tr_b16 a[2:3], v32 offset:512
    ds_read_b64_tr_b16 a[4:5], v33 offset:0
    ds_read_b64_tr_b16 a[6:7], v33 offset:512
    ds_read_b64_tr_b16 a[8:9], v32 offset:2048
    ds_read_b64_tr_b16 a[10:11], v32 offset:2560
    ds_read_b64_tr_b16 a[12:13], v33 offset:2048
    ds_read_b64_tr_b16 a[14:15], v33 offset:2560
    ds_read_b64_tr_b16 a[16:17], v32 offset:4096
    ds_read_b64_tr_b16 a[18:19], v32 offset:4608
    ds_read_b64_tr_b16 a[20:21], v33 offset:4096
    ds_read_b64_tr_b16 a[22:23], v33 offset:4608
    ds_read_b64_tr_b16 a[24:25], v32 offset:6144
    ds_read_b64_tr_b16 a[26:27], v32 offset:6656
    ds_read_b64_tr_b16 a[28:29], v33 offset:6144
    ds_read_b64_tr_b16 a[30:31], v33 offset:6656
    ds_read_b64_tr_b16 a[32:33], v32 offset:8192
    ds_read_b64_tr_b16 a[34:35], v32 offset:8704
    ds_read_b64_tr_b16 a[36:37], v33 offset:8192
    ds_read_b64_tr_b16 a[38:39], v33 offset:8704
    ds_read_b64_tr_b16 a[40:41], v32 offset:10240
    ds_read_b64_tr_b16 a[42:43], v32 offset:10752
    ds_read_b64_tr_b16 a[44:45], v33 offset:10240
    ds_read_b64_tr_b16 a[46:47], v33 offset:10752
    ds_read_b64_tr_b16 a[48:49], v32 offset:12288
    ds_read_b64_tr_b16 a[50:51], v32 offset:12800
    ds_read_b64_tr_b16 a[52:53], v33 offset:12288
    ds_read_b64_tr_b16 a[54:55], v33 offset:12800
    ds_read_b64_tr_b16 a[56:57], v32 offset:14336
    ds_read_b64_tr_b16 a[58:59], v32 offset:14848
    ds_read_b64_tr_b16 a[60:61], v33 offset:14336
    ds_read_b64_tr_b16 a[62:63], v33 offset:14848
    s_lshl_b32 s18, s79, 15
    s_add_u32 s18, s18, 5242880
    s_lshl_b32 s19, s60, 13
    s_add_u32 s72, s3, 0
    s_mul_hi_u32 s74, s72, 0x55555556
    s_mul_i32 s74, s74, 3
    s_sub_u32 s72, s72, s74
    s_lshl_b32 s72, s72, 15
    s_add_u32 s89, s72, s18
    s_add_u32 s72, s72, s19
    s_add_u32 s92, s72, 32768
    s_add_u32 s72, s3, 1
    s_mul_hi_u32 s74, s72, 0x55555556
    s_mul_i32 s74, s74, 3
    s_sub_u32 s72, s72, s74
    s_lshl_b32 s72, s72, 15
    s_add_u32 s90, s72, s18
    s_add_u32 s72, s72, s19
    s_add_u32 s93, s72, 32768
    s_add_u32 s72, s3, 2
    s_mul_hi_u32 s74, s72, 0x55555556
    s_mul_i32 s74, s74, 3
    s_sub_u32 s72, s72, s74
    s_lshl_b32 s72, s72, 15
    s_add_u32 s91, s72, s18
    s_add_u32 s72, s72, s19
    s_add_u32 s94, s72, 32768
    s_and_b32 s72, s60, 1
    s_lshl1_add_u32 s72, s66, s72
    s_lshl2_add_u32 s72, s72, s60
    s_lshl_b32 s72, s72, 13
    s_add_u32 s84, s72, 1048576
    s_xor_b32 s85, s84, 32768
    s_add_u32 s86, s84, 4096
    s_add_u32 s87, s85, 4096
    s_mul_i32 s16, s60, 9216
    s_add_u32 s17, s16, 4608
    s_add_u32 s74, s66, 64
    s_lshl_b32 s74, s74, 7
    s_add_u32 s74, s74, 36864
    s_sub_u32 s74, s74, 36864
    v_mov_b32 v2, s74
    v_cmp_gt_u32 vcc, 8, v1
    v_mov_b32 v3, 32
    s_nop 0
    v_cndmask_b32 v2, v2, v249, vcc
    v_cndmask_b32 v3, 8, v3, vcc
    s_cmp_lg_u32 s60, 1
    s_cbranch_scc1 L_sk_15
    s_mov_b32 exec_lo, 0x1ff
    s_mov_b32 exec_hi, 0x0
    s_mov_b32 s82, 0
    s_sleep 1
L_poll_16:
    buffer_load_dword v243, v2, s[32:35], s21 offen sc1
    s_add_u32 s82, s82, 1
    s_cmp_gt_u32 s82, 0x40000
    s_cbranch_scc1 L_end
    s_waitcnt vmcnt(0)
    v_cmp_gt_u32 vcc, v3, v243
    s_cbranch_vccz L_pok_17
    s_sleep 2
    s_branch L_poll_16
L_pok_17:
    s_mov_b64 exec, -1
    s_and_b32 s95, vcc_lo, 0xff
L_sk_15:
    s_lshr_b32 s72, s2, 5
    s_lshl_b32 s72, s72, 7
    s_add_u32 s72, s72, 57344
    v_lshlrev_b32 v241, 10, v1
    s_waitcnt vmcnt(0)
    s_waitcnt lgkmcnt(0)
    s_barrier
    s_cmp_lg_u32 s60, 0
    s_cbranch_scc1 L_sk_18
    s_mov_b32 exec_lo, 0xff
    s_mov_b32 exec_hi, 0x0
    buffer_atomic_add v23, v241, s[32:35], s72 offen sc1
    s_mov_b64 exec, -1
L_sk_18:
    s_add_u32 m0, s19, 65536
    s_nop 0
    buffer_load_dwordx4 v21, s[32:35], s16 offen sc1 lds
    buffer_load_dwordx4 v21, s[32:35], s16 offen offset:1024 sc1 lds
    buffer_load_dwordx4 v21, s[32:35], s16 offen offset:2048 sc1 lds
    buffer_load_dwordx4 v21, s[32:35], s16 offen offset:3072 sc1 lds
    s_add_u32 m0, m0, 1024
    s_add_u32 s72, s16, 1024
    buffer_load_dwordx4 v21, s[32:35], s72 offen offset:3072 sc1 lds
    buffer_load_dwordx4 a[68:71], v244, s[32:35], s85 offen offset:0 sc1
    buffer_load_dwordx4 a[76:79], v244, s[32:35], s85 offen offset:1024 sc1
    s_add_u32 m0, s19, 98304
    s_nop 0
    buffer_load_dwordx4 v21, s[32:35], s17 offen sc1 lds
    buffer_load_dwordx4 v21, s[32:35], s17 offen offset:1024 sc1 lds
    buffer_load_dwordx4 v21, s[32:35], s17 offen offset:2048 sc1 lds
    buffer_load_dwordx4 v21, s[32:35], s17 offen offset:3072 sc1 lds
    s_add_u32 m0, m0, 1024
    s_add_u32 s72, s17, 1024
    buffer_load_dwordx4 v21, s[32:35], s72 offen offset:3072 sc1 lds
    buffer_load_dwordx4 a[84:87], v244, s[32:35], s85 offen offset:2048 sc1
    buffer_load_dwordx4 a[92:95], v244, s[32:35], s85 offen offset:3072 sc1
    buffer_load_dwordx4 a[100:103], v244, s[32:35], s87 offen offset:0 sc1
    buffer_load_dwordx4 a[108:111], v244, s[32:35], s87 offen offset:1024 sc1
    s_lshl_b32 s72, s60, 12
    v_add_u32 v2, s72, v21
    v_add_u32 v3, 131072, v2
    v_xor_b32 v24, 4096, v2
    v_xor_b32 v25, 8192, v2
    v_xor_b32 v254, 12288, v3
    s_waitcnt vmcnt(11)
    ds_read_b128 v[28:31], v245 offset:0
    ds_read_b128 v[32:35], v245 offset:16
    ds_read_b128 v[36:39], v245 offset:1152
    ds_read_b128 v[40:43], v245 offset:1168
    ds_read_b128 v[44:47], v245 offset:2304
    ds_read_b128 v[48:51], v245 offset:2320
    ds_read_b128 v[52:55], v245 offset:3456
    ds_read_b128 v[56:59], v245 offset:3472
    s_waitcnt lgkmcnt(6)
    v_cvt_pk_bf16_f32 v92, v28, v29
    v_cvt_pk_bf16_f32 v93, v30, v31
    v_cvt_pk_bf16_f32 v94, v32, v33
    v_cvt_pk_bf16_f32 v95, v34, v35
    s_waitcnt vmcnt(10)
    s_nop 0
    v_mfma_f32_32x32x16_bf16 v[188:203], v[92:95], a[68:71], v[4:19]
    s_waitcnt lgkmcnt(4)
    v_cvt_pk_bf16_f32 v96, v36, v37
    v_cvt_pk_bf16_f32 v97, v38, v39
    v_cvt_pk_bf16_f32 v98, v40, v41
    v_cvt_pk_bf16_f32 v99, v42, v43
    s_waitcnt vmcnt(4)
    ds_read_b128 v[60:63], v245 offset:32768
    ds_read_b128 v[64:67], v245 offset:32784
    ds_read_b128 v[68:71], v245 offset:33920
    ds_read_b128 v[72:75], v245 offset:33936
    ds_read_b128 v[76:79], v245 offset:35072
    ds_read_b128 v[80:83], v245 offset:35088
    ds_read_b128 v[84:87], v245 offset:36224
    ds_read_b128 v[88:91], v245 offset:36240
    v_mfma_f32_32x32x16_bf16 v[204:219], v[96:99], a[76:79], v[4:19]
    s_waitcnt lgkmcnt(10)
    v_cvt_pk_bf16_f32 v100, v44, v45
    v_cvt_pk_bf16_f32 v101, v46, v47
    v_cvt_pk_bf16_f32 v102, v48, v49
    v_cvt_pk_bf16_f32 v103, v50, v51
    s_waitcnt vmcnt(3)
    s_nop 0
    v_mfma_f32_32x32x16_bf16 v[28:43], v[100:103], a[84:87], v[4:19]
    buffer_load_dwordx4 a[116:119], v244, s[32:35], s87 offen offset:2048 sc1
    v_rcp_f32 v196, v196
    s_waitcnt lgkmcnt(8)
    v_cvt_pk_bf16_f32 v104, v52, v53
    v_cvt_pk_bf16_f32 v105, v54, v55
    v_cvt_pk_bf16_f32 v106, v56, v57
    v_cvt_pk_bf16_f32 v107, v58, v59
    v_mul_f32 v188, v188, v196
    v_mul_f32 v189, v189, v196
    v_mul_f32 v190, v190, v196
    v_mul_f32 v191, v191, v196
    v_mul_f32 v192, v192, v196
    v_mul_f32 v193, v193, v196
    v_mul_f32 v194, v194, v196
    v_mul_f32 v195, v195, v196
    v_cvt_pk_bf16_f32 v220, v188, v189
    v_cvt_pk_bf16_f32 v221, v190, v191
    v_cvt_pk_bf16_f32 v222, v192, v193
    v_cvt_pk_bf16_f32 v223, v194, v195
    s_nop 1
    v_mfma_f32_32x32x16_bf16 v[172:187], a[4:7], v[220:223], 0
    buffer_load_dwordx4 a[124:127], v244, s[32:35], s87 offen offset:3072 sc1
    v_rcp_f32 v212, v212
    s_waitcnt lgkmcnt(6)
    v_cvt_pk_bf16_f32 v108, v60, v61
    v_mfma_f32_32x32x16_bf16 v[140:155], a[0:3], v[220:223], 0
    s_waitcnt vmcnt(4)
    buffer_load_dwordx4 a[64:67], v244, s[32:35], s84 offen offset:0 sc1
    v_cvt_pk_bf16_f32 v109, v62, v63
    v_cvt_pk_bf16_f32 v110, v64, v65
    v_cvt_pk_bf16_f32 v111, v66, v67
    v_mul_f32 v204, v204, v212
    v_mfma_f32_32x32x16_bf16 v[188:203], v[104:107], a[92:95], v[4:19]
    buffer_load_dwordx4 a[72:75], v244, s[32:35], s84 offen offset:1024 sc1
    v_mul_f32 v205, v205, v212
    v_mul_f32 v206, v206, v212
    v_mul_f32 v207, v207, v212
    v_mul_f32 v208, v208, v212
    v_mul_f32 v209, v209, v212
    v_mul_f32 v210, v210, v212
    v_mul_f32 v211, v211, v212
    v_cvt_pk_bf16_f32 v224, v204, v205
    v_cvt_pk_bf16_f32 v225, v206, v207
    v_cvt_pk_bf16_f32 v226, v208, v209
    v_cvt_pk_bf16_f32 v227, v210, v211
    s_nop 1
    v_mfma_f32_32x32x16_bf16 v[172:187], a[12:15], v[224:227], v[172:187]
    buffer_load_dwordx4 a[80:83], v244, s[32:35], s84 offen offset:2048 sc1
    v_rcp_f32 v36, v36
    s_waitcnt lgkmcnt(4)
    v_cvt_pk_bf16_f32 v112, v68, v69
    v_mfma_f32_32x32x16_bf16 v[140:155], a[8:11], v[224:227], v[140:155]
    s_waitcnt vmcnt(6)
    buffer_load_dwordx4 a[88:91], v244, s[32:35], s84 offen offset:3072 sc1
    v_cvt_pk_bf16_f32 v113, v70, v71
    v_cvt_pk_bf16_f32 v114, v72, v73
    v_cvt_pk_bf16_f32 v115, v74, v75
    v_mul_f32 v28, v28, v36
    v_mfma_f32_32x32x16_bf16 v[204:219], v[108:111], a[100:103], v[4:19]
    buffer_load_dwordx4 a[96:99], v244, s[32:35], s86 offen offset:0 sc1
    v_mul_f32 v29, v29, v36
    v_mul_f32 v30, v30, v36
    v_mul_f32 v31, v31, v36
    v_mul_f32 v32, v32, v36
    v_mul_f32 v33, v33, v36
    v_mul_f32 v34, v34, v36
    v_mul_f32 v35, v35, v36
    v_cvt_pk_bf16_f32 v220, v28, v29
    v_cvt_pk_bf16_f32 v221, v30, v31
    v_cvt_pk_bf16_f32 v222, v32, v33
    v_cvt_pk_bf16_f32 v223, v34, v35
    s_nop 1
    v_mfma_f32_32x32x16_bf16 v[172:187], a[20:23], v[220:223], v[172:187]
    buffer_load_dwordx4 a[104:107], v244, s[32:35], s86 offen offset:1024 sc1
    v_rcp_f32 v196, v196
    s_waitcnt lgkmcnt(2)
    v_cvt_pk_bf16_f32 v116, v76, v77
    v_mfma_f32_32x32x16_bf16 v[140:155], a[16:19], v[220:223], v[140:155]
    s_waitcnt vmcnt(8)
    buffer_load_dwordx4 a[112:115], v244, s[32:35], s86 offen offset:2048 sc1
    v_cvt_pk_bf16_f32 v117, v78, v79
    v_cvt_pk_bf16_f32 v118, v80, v81
    v_cvt_pk_bf16_f32 v119, v82, v83
    v_mul_f32 v188, v188, v196
    v_mfma_f32_32x32x16_bf16 v[28:43], v[112:115], a[108:111], v[4:19]
    buffer_load_dwordx4 a[120:123], v244, s[32:35], s86 offen offset:3072 sc1
    v_mul_f32 v189, v189, v196
    v_mul_f32 v190, v190, v196
    v_mul_f32 v191, v191, v196
    v_mul_f32 v192, v192, v196
    v_mul_f32 v193, v193, v196
    v_mul_f32 v194, v194, v196
    v_mul_f32 v195, v195, v196
    v_cvt_pk_bf16_f32 v224, v188, v189
    v_cvt_pk_bf16_f32 v225, v190, v191
    v_cvt_pk_bf16_f32 v226, v192, v193
    v_cvt_pk_bf16_f32 v227, v194, v195
    s_nop 1
    v_mfma_f32_32x32x16_bf16 v[172:187], a[28:31], v[224:227], v[172:187]
    s_mov_b32 s95, 57344
    v_rcp_f32 v212, v212
    s_waitcnt lgkmcnt(0)
    v_cvt_pk_bf16_f32 v120, v84, v85
    v_cvt_pk_bf16_f32 v121, v86, v87
    v_cvt_pk_bf16_f32 v122, v88, v89
    v_mfma_f32_32x32x16_bf16 v[140:155], a[24:27], v[224:227], v[140:155]
    s_waitcnt vmcnt(9)
    v_cvt_pk_bf16_f32 v123, v90, v91
    v_mul_f32 v204, v204, v212
    v_mul_f32 v205, v205, v212
    v_mul_f32 v206, v206, v212
    v_mul_f32 v207, v207, v212
    v_mul_f32 v208, v208, v212
    v_mfma_f32_32x32x16_bf16 v[188:203], v[116:119], a[116:119], v[4:19]
    v_mul_f32 v209, v209, v212
    v_mul_f32 v210, v210, v212
    v_mul_f32 v211, v211, v212
    v_cvt_pk_bf16_f32 v220, v204, v205
    v_cvt_pk_bf16_f32 v221, v206, v207
    v_cvt_pk_bf16_f32 v222, v208, v209
    v_cvt_pk_bf16_f32 v223, v210, v211
    s_nop 1
    v_mfma_f32_32x32x16_bf16 v[172:187], a[36:39], v[220:223], v[172:187]
    v_rcp_f32 v36, v36
    s_nop 0
    v_mul_f32 v28, v28, v36
    v_mul_f32 v29, v29, v36
    v_mul_f32 v30, v30, v36
    v_mul_f32 v31, v31, v36
    v_mfma_f32_32x32x16_bf16 v[140:155], a[32:35], v[220:223], v[140:155]
    s_waitcnt vmcnt(8)
    v_mul_f32 v32, v32, v36
    v_mul_f32 v33, v33, v36
    v_mul_f32 v34, v34, v36
    v_mul_f32 v35, v35, v36
    v_cvt_pk_bf16_f32 v224, v28, v29
    v_cvt_pk_bf16_f32 v225, v30, v31
    v_mfma_f32_32x32x16_bf16 v[204:219], v[120:123], a[124:127], v[4:19]
    v_cvt_pk_bf16_f32 v226, v32, v33
    v_cvt_pk_bf16_f32 v227, v34, v35
    s_nop 1
    v_mfma_f32_32x32x16_bf16 v[172:187], a[44:47], v[224:227], v[172:187]
    buffer_load_dword v250, v249, s[32:35], s95 offen sc1
    v_rcp_f32 v196, v196
    s_nop 0
    v_mul_f32 v188, v188, v196
    v_mul_f32 v189, v189, v196
    v_mfma_f32_32x32x16_bf16 v[140:155], a[40:43], v[224:227], v[140:155]
    s_waitcnt vmcnt(8)
    v_mul_f32 v190, v190, v196
    v_mul_f32 v191, v191, v196
    v_mul_f32 v192, v192, v196
    v_mul_f32 v193, v193, v196
    v_mul_f32 v194, v194, v196
    v_mul_f32 v195, v195, v196
    v_mfma_f32_32x32x16_bf16 v[28:43], v[92:95], a[64:67], v[4:19]
    v_cvt_pk_bf16_f32 v220, v188, v189
    v_cvt_pk_bf16_f32 v221, v190, v191
    v_cvt_pk_bf16_f32 v222, v192, v193
    v_cvt_pk_bf16_f32 v223, v194, v195
    s_nop 1
    v_mfma_f32_32x32x16_bf16 v[172:187], a[52:55], v[220:223], v[172:187]
    v_rcp_f32 v212, v212
    s_nop 0
    v_mul_f32 v204, v204, v212
    v_mul_f32 v205, v205, v212
    v_mul_f32 v206, v206, v212
    v_mul_f32 v207, v207, v212
    v_mfma_f32_32x32x16_bf16 v[140:155], a[48:51], v[220:223], v[140:155]
    s_waitcnt vmcnt(7)
    v_mul_f32 v208, v208, v212
    v_mul_f32 v209, v209, v212
    v_mul_f32 v210, v210, v212
    v_mul_f32 v211, v211, v212
    v_cvt_pk_bf16_f32 v224, v204, v205
    v_cvt_pk_bf16_f32 v225, v206, v207
    v_mfma_f32_32x32x16_bf16 v[188:203], v[96:99], a[72:75], v[4:19]
    v_cvt_pk_bf16_f32 v226, v208, v209
    v_cvt_pk_bf16_f32 v227, v210, v211
    s_nop 1
    v_mfma_f32_32x32x16_bf16 v[172:187], a[60:63], v[224:227], v[172:187]
    v_rcp_f32 v36, v36
    s_nop 0
    v_mul_f32 v28, v28, v36
    v_mul_f32 v29, v29, v36
    v_mul_f32 v30, v30, v36
    v_mul_f32 v31, v31, v36
    v_mfma_f32_32x32x16_bf16 v[140:155], a[56:59], v[224:227], v[140:155]
    s_waitcnt vmcnt(6)
    v_mul_f32 v32, v32, v36
    v_mul_f32 v33, v33, v36
    v_mul_f32 v34, v34, v36
    v_mul_f32 v35, v35, v36
    v_cvt_pk_bf16_f32 v220, v28, v29
    v_cvt_pk_bf16_f32 v221, v30, v31
    v_mfma_f32_32x32x16_bf16 v[204:219], v[100:103], a[80:83], v[4:19]
    v_cvt_pk_bf16_f32 v222, v32, v33
    v_cvt_pk_bf16_f32 v223, v34, v35
    s_nop 1
    v_mfma_f32_32x32x16_bf16 v[156:171], a[4:7], v[220:223], 0
    ds_write_b128 v3, v[172:175] offset:0
    v_rcp_f32 v196, v196
    s_nop 0
    v_mul_f32 v188, v188, v196
    v_mul_f32 v189, v189, v196
    v_mul_f32 v190, v190, v196
    v_mfma_f32_32x32x16_bf16 v[124:139], a[0:3], v[220:223], 0
    s_waitcnt vmcnt(5)
    ds_write_b128 v3, v[176:179] offset:1024
    v_mul_f32 v191, v191, v196
    v_mul_f32 v192, v192, v196
    v_mul_f32 v193, v193, v196
    v_mul_f32 v194, v194, v196
    v_mul_f32 v195, v195, v196
    v_mfma_f32_32x32x16_bf16 v[28:43], v[104:107], a[88:91], v[4:19]
    ds_write_b128 v3, v[180:183] offset:2048
    v_cvt_pk_bf16_f32 v224, v188, v189
    v_cvt_pk_bf16_f32 v225, v190, v191
    v_cvt_pk_bf16_f32 v226, v192, v193
    v_cvt_pk_bf16_f32 v227, v194, v195
    s_nop 1
    v_mfma_f32_32x32x16_bf16 v[156:171], a[12:15], v[224:227], v[156:171]
    ds_write_b128 v3, v[184:187] offset:3072
    s_waitcnt vmcnt(0)
    v_cmp_gt_u32 vcc, 32, v250
    s_cbranch_vccz L_rpok_19
    s_mov_b32 exec_lo, 0xff
    s_mov_b32 exec_hi, 0x0
    s_mov_b32 s82, 0
L_poll_20:
    buffer_load_dword v250, v249, s[32:35], s95 offen sc1
    s_add_u32 s82, s82, 1
    s_cmp_gt_u32 s82, 0x40000
    s_cbranch_scc1 L_end
    s_waitcnt vmcnt(0)
    v_cmp_gt_u32 vcc, 32, v250
    s_cbranch_vccz L_pok_21
    s_sleep 2
    s_branch L_poll_20
L_pok_21:
    s_mov_b64 exec, -1
L_rpok_19:
    v_rcp_f32 v212, v212
    s_nop 0
    v_mul_f32 v204, v204, v212
    v_mfma_f32_32x32x16_bf16 v[124:139], a[8:11], v[224:227], v[124:139]
    s_mov_b32 m0, s92
    ds_write_b128 v2, v[140:143] offset:0
    buffer_load_dwordx4 v248, s[32:35], s89 offen offset:0 sc1 lds
    v_mul_f32 v205, v205, v212
    v_mul_f32 v206, v206, v212
    v_mul_f32 v207, v207, v212
    v_mfma_f32_32x32x16_bf16 v[188:203], v[108:111], a[96:99], v[4:19]
    ds_write_b128 v2, v[144:147] offset:1024
    buffer_load_dwordx4 v248, s[32:35], s89 offen offset:1024 sc1 lds
    v_mul_f32 v208, v208, v212
    v_mul_f32 v209, v209, v212
    v_mul_f32 v210, v210, v212
    v_mul_f32 v211, v211, v212
    v_cvt_pk_bf16_f32 v220, v204, v205
    v_cvt_pk_bf16_f32 v221, v206, v207
    v_cvt_pk_bf16_f32 v222, v208, v209
    v_cvt_pk_bf16_f32 v223, v210, v211
    s_nop 1
    v_mfma_f32_32x32x16_bf16 v[156:171], a[20:23], v[220:223], v[156:171]
    ds_write_b128 v2, v[148:151] offset:2048
    v_rcp_f32 v36, v36
    s_nop 0
    v_mul_f32 v28, v28, v36
    v_mul_f32 v29, v29, v36
    v_mul_f32 v30, v30, v36
    v_mfma_f32_32x32x16_bf16 v[124:139], a[16:19], v[220:223], v[124:139]
    ds_write_b128 v2, v[152:155] offset:3072
    buffer_load_dwordx4 v248, s[32:35], s89 offen offset:2048 sc1 lds
    v_mul_f32 v31, v31, v36
    v_mul_f32 v32, v32, v36
    v_mul_f32 v33, v33, v36
    v_mfma_f32_32x32x16_bf16 v[204:219], v[112:115], a[104:107], v[4:19]
    buffer_load_dwordx4 v248, s[32:35], s89 offen offset:3072 sc1 lds
    v_mul_f32 v34, v34, v36
    v_mul_f32 v35, v35, v36
    v_cvt_pk_bf16_f32 v224, v28, v29
    v_cvt_pk_bf16_f32 v225, v30, v31
    v_cvt_pk_bf16_f32 v226, v32, v33
    v_cvt_pk_bf16_f32 v227, v34, v35
    s_nop 1
    v_mfma_f32_32x32x16_bf16 v[156:171], a[28:31], v[224:227], v[156:171]
    s_waitcnt lgkmcnt(0)
    s_barrier
    v_rcp_f32 v196, v196
    s_nop 0
    v_mul_f32 v188, v188, v196
    v_mul_f32 v189, v189, v196
    v_mul_f32 v190, v190, v196
    v_mfma_f32_32x32x16_bf16 v[124:139], a[24:27], v[224:227], v[124:139]
    s_add_u32 m0, s92, 4096
    ds_read_b128 v[172:175], v254 offset:0
    buffer_load_dwordx4 v251, s[32:35], s89 offen offset:0 sc1 lds
    v_mul_f32 v191, v191, v196
    v_mul_f32 v192, v192, v196
    v_mul_f32 v193, v193, v196
    v_mfma_f32_32x32x16_bf16 v[28:43], v[116:119], a[112:115], v[4:19]
    ds_read_b128 v[176:179], v254 offset:1024
    buffer_load_dwordx4 v251, s[32:35], s89 offen offset:1024 sc1 lds
    v_mul_f32 v194, v194, v196
    v_mul_f32 v195, v195, v196
    v_cvt_pk_bf16_f32 v220, v188, v189
    v_cvt_pk_bf16_f32 v221, v190, v191
    v_cvt_pk_bf16_f32 v222, v192, v193
    v_cvt_pk_bf16_f32 v223, v194, v195
    s_nop 1
    v_mfma_f32_32x32x16_bf16 v[156:171], a[36:39], v[220:223], v[156:171]
    ds_read_b128 v[180:183], v254 offset:2048
    v_rcp_f32 v212, v212
    s_nop 0
    v_mul_f32 v204, v204, v212
    v_mul_f32 v205, v205, v212
    v_mul_f32 v206, v206, v212
    v_mfma_f32_32x32x16_bf16 v[124:139], a[32:35], v[220:223], v[124:139]
    ds_read_b128 v[184:187], v254 offset:3072
    buffer_load_dwordx4 v251, s[32:35], s89 offen offset:2048 sc1 lds
    v_mul_f32 v207, v207, v212
    v_mul_f32 v208, v208, v212
    v_mul_f32 v209, v209, v212
    v_mfma_f32_32x32x16_bf16 v[188:203], v[120:123], a[120:123], v[4:19]
    ds_read_b128 v[140:143], v24 offset:0
    buffer_load_dwordx4 v251, s[32:35], s89 offen offset:3072 sc1 lds
    v_mul_f32 v210, v210, v212
    v_mul_f32 v211, v211, v212
    v_cvt_pk_bf16_f32 v224, v204, v205
    v_cvt_pk_bf16_f32 v225, v206, v207
    v_cvt_pk_bf16_f32 v226, v208, v209
    v_cvt_pk_bf16_f32 v227, v210, v211
    s_nop 1
    v_mfma_f32_32x32x16_bf16 v[156:171], a[44:47], v[224:227], v[156:171]
    s_mov_b32 m0, s93
    ds_read_b128 v[144:147], v24 offset:1024
    v_rcp_f32 v36, v36
    s_nop 0
    v_mul_f32 v28, v28, v36
    v_mul_f32 v29, v29, v36
    v_mul_f32 v30, v30, v36
    v_mfma_f32_32x32x16_bf16 v[124:139], a[40:43], v[224:227], v[124:139]
    ds_read_b128 v[148:151], v24 offset:2048
    buffer_load_dwordx4 v248, s[32:35], s90 offen offset:0 sc1 lds
    v_mul_f32 v31, v31, v36
    v_mul_f32 v32, v32, v36
    v_mul_f32 v33, v33, v36
    v_mul_f32 v34, v34, v36
    v_mul_f32 v35, v35, v36
    v_cvt_pk_bf16_f32 v220, v28, v29
    v_cvt_pk_bf16_f32 v221, v30, v31
    v_cvt_pk_bf16_f32 v222, v32, v33
    v_cvt_pk_bf16_f32 v223, v34, v35
    s_nop 1
    v_mfma_f32_32x32x16_bf16 v[156:171], a[52:55], v[220:223], v[156:171]
    ds_read_b128 v[152:155], v24 offset:3072
    buffer_load_dwordx4 v248, s[32:35], s90 offen offset:1024 sc1 lds
    v_rcp_f32 v196, v196
    s_nop 0
    v_mul_f32 v188, v188, v196
    v_mfma_f32_32x32x16_bf16 v[124:139], a[48:51], v[220:223], v[124:139]
    buffer_load_dwordx4 v248, s[32:35], s90 offen offset:2048 sc1 lds
    v_mul_f32 v189, v189, v196
    v_mul_f32 v190, v190, v196
    v_mul_f32 v191, v191, v196
    v_mul_f32 v192, v192, v196
    v_mul_f32 v193, v193, v196
    v_mul_f32 v194, v194, v196
    v_mul_f32 v195, v195, v196
    v_cvt_pk_bf16_f32 v224, v188, v189
    v_cvt_pk_bf16_f32 v225, v190, v191
    v_cvt_pk_bf16_f32 v226, v192, v193
    v_cvt_pk_bf16_f32 v227, v194, v195
    s_nop 1
    v_mfma_f32_32x32x16_bf16 v[156:171], a[60:63], v[224:227], v[156:171]
    buffer_load_dwordx4 v248, s[32:35], s90 offen offset:3072 sc1 lds
    v_mfma_f32_32x32x16_bf16 v[124:139], a[56:59], v[224:227], v[124:139]
    s_nop 9
    ds_write_b128 v2, v[156:159] offset:16384
    ds_write_b128 v2, v[160:163] offset:17408
    ds_write_b128 v2, v[164:167] offset:18432
    ds_write_b128 v2, v[168:171] offset:19456
    s_waitcnt lgkmcnt(4)
    v_pk_add_f32 v[140:141], v[140:141], v[172:173]
    v_pk_add_f32 v[142:143], v[142:143], v[174:175]
    v_pk_add_f32 v[144:145], v[144:145], v[176:177]
    v_pk_add_f32 v[146:147], v[146:147], v[178:179]
    v_pk_add_f32 v[148:149], v[148:149], v[180:181]
    v_pk_add_f32 v[150:151], v[150:151], v[182:183]
    v_pk_add_f32 v[152:153], v[152:153], v[184:185]
    v_pk_add_f32 v[154:155], v[154:155], v[186:187]
    v_lshlrev_b32 v172, 16, v232
    v_and_b32 v173, 0xffff0000, v232
    v_lshlrev_b32 v174, 16, v233
    v_and_b32 v175, 0xffff0000, v233
    v_lshlrev_b32 v176, 16, v234
    v_and_b32 v177, 0xffff0000, v234
    v_lshlrev_b32 v178, 16, v235
    v_and_b32 v179, 0xffff0000, v235
    v_lshlrev_b32 v180, 16, v236
    v_and_b32 v181, 0xffff0000, v236
    v_lshlrev_b32 v182, 16, v237
    v_and_b32 v183, 0xffff0000, v237
    v_lshlrev_b32 v184, 16, v238
    v_and_b32 v185, 0xffff0000, v238
    v_lshlrev_b32 v186, 16, v239
    v_and_b32 v187, 0xffff0000, v239
    v_pk_add_f32 v[140:141], v[140:141], v[172:173]
    v_pk_add_f32 v[142:143], v[142:143], v[174:175]
    v_pk_add_f32 v[144:145], v[144:145], v[176:177]
    v_pk_add_f32 v[146:147], v[146:147], v[178:179]
    v_pk_add_f32 v[148:149], v[148:149], v[180:181]
    v_pk_add_f32 v[150:151], v[150:151], v[182:183]
    v_pk_add_f32 v[152:153], v[152:153], v[184:185]
    v_pk_add_f32 v[154:155], v[154:155], v[186:187]
    s_and_b32 s72, s60, 1
    s_lshl1_add_u32 s72, s66, s72
    s_lshr_b32 s73, s60, 1
    s_lshl1_add_u32 s73, s67, s73
    s_lshl4_add_u32 s72, s72, s73
    s_lshl_b32 s85, s72, 11
    s_add_u32 s85, s85, 3145728
    s_lshl_b32 s84, s72, 8
    s_add_u32 s84, s84, 131072
    v_pk_add_f32 v[124:125], v[124:125], v[140:141]
    v_pk_add_f32 v[126:127], v[126:127], v[142:143]
    v_pk_add_f32 v[128:129], v[128:129], v[144:145]
    v_pk_add_f32 v[130:131], v[130:131], v[146:147]
    v_pk_add_f32 v[132:133], v[132:133], v[148:149]
    v_pk_add_f32 v[134:135], v[134:135], v[150:151]
    v_pk_add_f32 v[136:137], v[136:137], v[152:153]
    v_pk_add_f32 v[138:139], v[138:139], v[154:155]
    s_waitcnt lgkmcnt(0)
    s_barrier
    ds_read_b128 v[156:159], v25 offset:16384
    ds_read_b128 v[160:163], v25 offset:17408
    ds_read_b128 v[164:167], v25 offset:18432
    ds_read_b128 v[168:171], v25 offset:19456
    s_waitcnt lgkmcnt(3)
    v_pk_add_f32 v[124:125], v[124:125], v[156:157]
    v_pk_add_f32 v[126:127], v[126:127], v[158:159]
    v_cvt_pk_bf16_f32 v232, v124, v125
    v_cvt_pk_bf16_f32 v233, v126, v127
    s_waitcnt lgkmcnt(2)
    v_pk_add_f32 v[128:129], v[128:129], v[160:161]
    v_pk_add_f32 v[130:131], v[130:131], v[162:163]
    v_cvt_pk_bf16_f32 v234, v128, v129
    v_cvt_pk_bf16_f32 v235, v130, v131
    s_waitcnt lgkmcnt(1)
    v_pk_add_f32 v[132:133], v[132:133], v[164:165]
    v_pk_add_f32 v[134:135], v[134:135], v[166:167]
    v_cvt_pk_bf16_f32 v236, v132, v133
    v_cvt_pk_bf16_f32 v237, v134, v135
    s_waitcnt lgkmcnt(0)
    v_pk_add_f32 v[136:137], v[136:137], v[168:169]
    v_pk_add_f32 v[138:139], v[138:139], v[170:171]
    v_cvt_pk_bf16_f32 v238, v136, v137
    v_cvt_pk_bf16_f32 v239, v138, v139
    buffer_store_dwordx4 v[232:235], v21, s[32:35], s85 offen sc1
    buffer_store_dwordx4 v[236:239], v21, s[32:35], s85 offen offset:1024 sc1
    v_pk_add_f32 v[156:157], v[124:125], v[126:127]
    v_pk_mul_f32 v[158:159], v[124:125], v[124:125]
    v_pk_fma_f32 v[158:159], v[126:127], v[126:127], v[158:159]
    v_pk_add_f32 v[156:157], v[156:157], v[128:129]
    v_pk_fma_f32 v[158:159], v[128:129], v[128:129], v[158:159]
    v_pk_add_f32 v[156:157], v[156:157], v[130:131]
    v_pk_fma_f32 v[158:159], v[130:131], v[130:131], v[158:159]
    v_pk_add_f32 v[156:157], v[156:157], v[132:133]
    v_pk_fma_f32 v[158:159], v[132:133], v[132:133], v[158:159]
    v_pk_add_f32 v[156:157], v[156:157], v[134:135]
    v_pk_fma_f32 v[158:159], v[134:135], v[134:135], v[158:159]
    v_pk_add_f32 v[156:157], v[156:157], v[136:137]
    v_pk_fma_f32 v[158:159], v[136:137], v[136:137], v[158:159]
    v_pk_add_f32 v[156:157], v[156:157], v[138:139]
    v_pk_fma_f32 v[158:159], v[138:139], v[138:139], v[158:159]
    v_add_f32 v156, v156, v157
    v_add_f32 v158, v158, v159
    s_nop 1
    v_permlane32_swap_b32 v156, v158
    v_add_f32 v156, v156, v158
    buffer_store_dword v156, v22, s[32:35], s84 offen sc1
    s_lshl1_add_u32 s72, s60, s79
    s_lshl_b32 s72, s72, 10
    s_add_u32 s72, s72, 393216
    buffer_load_dword v204, v252, s[32:35], s72 offen offset:0 sc1
    buffer_load_dword v205, v252, s[32:35], s72 offen offset:128 sc1
    buffer_load_dword v206, v252, s[32:35], s72 offen offset:256 sc1
    buffer_load_dword v207, v252, s[32:35], s72 offen offset:384 sc1
    buffer_load_dword v208, v252, s[32:35], s72 offen offset:512 sc1
    buffer_load_dword v209, v252, s[32:35], s72 offen offset:640 sc1
    buffer_load_dword v210, v252, s[32:35], s72 offen offset:768 sc1
    buffer_load_dword v211, v252, s[32:35], s72 offen offset:896 sc1
    s_add_u32 m0, s93, 4096
    s_nop 0
    buffer_load_dwordx4 v251, s[32:35], s90 offen offset:0 sc1 lds
    buffer_load_dwordx4 v251, s[32:35], s90 offen offset:1024 sc1 lds
    buffer_load_dwordx4 v251, s[32:35], s90 offen offset:2048 sc1 lds
    buffer_load_dwordx4 v251, s[32:35], s90 offen offset:3072 sc1 lds
    s_lshl_b32 s72, s88, 15
    s_add_u32 s72, s72, 3145728
    v_add_u32 v244, s72, v21
    s_lshr_b32 s72, s60, 1
    s_lshl1_add_u32 s72, s67, s72
    s_lshl_b32 s72, s72, 10
    s_add_u32 s72, s72, 8126464
    v_add_u32 v245, s72, v21
    v_xor_b32 v249, 1024, v245
    s_and_b32 s72, s60, 1
    s_lshl1_add_u32 s72, s66, s72
    s_xor_b32 s73, s72, 1
    s_mul_i32 s72, s72, 88064
    s_add_u32 s72, s72, 9568256
    v_add_u32 v250, s72, v21
    s_mul_i32 s73, s73, 88064
    s_add_u32 s73, s73, 9568256
    v_add_u32 v253, s73, v21
    s_lshr_b32 s72, s66, 1
    s_lshl_b32 s72, s72, 8
    s_add_u32 s84, s72, 49152
    s_lshl1_add_u32 s74, s68, s81
    s_lshl_b32 s74, s74, 7
    s_add_u32 s85, s74, 49152
    s_waitcnt vmcnt(12)
    s_barrier
    s_cmp_lg_u32 s60, 0
    s_cbranch_scc1 L_sk_22
    s_mov_b64 exec, 3
    buffer_atomic_add v23, v242, s[32:35], s84 offen sc1
    s_mov_b64 exec, -1
L_sk_22:
    s_mov_b32 m0, s94
    s_nop 0
    buffer_load_dwordx4 v248, s[32:35], s91 offen offset:0 sc1 lds
    buffer_load_dwordx4 v248, s[32:35], s91 offen offset:1024 sc1 lds
    buffer_load_dwordx4 v248, s[32:35], s91 offen offset:2048 sc1 lds
    buffer_load_dwordx4 v248, s[32:35], s91 offen offset:3072 sc1 lds
    s_add_u32 m0, s94, 4096
    s_nop 0
    buffer_load_dwordx4 v251, s[32:35], s91 offen offset:0 sc1 lds
    buffer_load_dwordx4 v251, s[32:35], s91 offen offset:1024 sc1 lds
    buffer_load_dwordx4 v251, s[32:35], s91 offen offset:2048 sc1 lds
    buffer_load_dwordx4 v251, s[32:35], s91 offen offset:3072 sc1 lds
    s_lshl_b32 s86, s67, 12
    s_lshl_b32 s87, s88, 12
    s_add_u32 s87, s87, 131072
    s_mul_i32 s16, s88, 86
    s_add_u32 s16, s16, s79
    s_lshl_b32 s16, s16, 10
    s_add_u32 s16, s16, 9568256
    s_add_u32 s17, s16, 4096
    s_waitcnt vmcnt(12)
    v_add_f32 v204, v204, v208
    v_add_f32 v205, v205, v209
    v_add_f32 v206, v206, v210
    v_add_f32 v207, v207, v211
    v_add_f32 v204, v204, v206
    v_add_f32 v205, v205, v207
    v_add_f32 v204, v204, v205
    s_lshl_b32 s72, s60, 8
    s_add_u32 s72, s72, 151552
    v_add_u32 v2, s72, v22
    ds_write_b32 v2, v204
    s_waitcnt vmcnt(0) lgkmcnt(0)
    s_cmp_lg_u32 s60, 1
    s_cbranch_scc1 L_sk_23
    s_mov_b64 exec, 1
    s_mov_b32 s82, 0
L_poll_24:
    buffer_load_dword v243, v242, s[32:35], s85 offen sc1
    s_add_u32 s82, s82, 1
    s_cmp_gt_u32 s82, 0x40000
    s_cbranch_scc1 L_end
    s_waitcnt vmcnt(0)
    v_cmp_gt_u32 vcc, 16, v243
    s_cbranch_vccz L_pok_25
    s_sleep 2
    s_branch L_poll_24
L_pok_25:
    s_mov_b64 exec, -1
L_sk_23:
    s_barrier
    buffer_load_dwordx4 a[176:179], v244, s[32:35], s86 offen offset:0 sc1
    buffer_load_dwordx4 a[180:183], v244, s[32:35], s86 offen offset:1024 sc1
    buffer_load_dwordx4 a[184:187], v244, s[32:35], s86 offen offset:2048 sc1
    buffer_load_dwordx4 a[188:191], v244, s[32:35], s86 offen offset:3072 sc1
    s_add_u32 s86, s86, 4096
    s_and_b32 s86, s86, 0x7fff
    buffer_load_dwordx4 a[192:195], v244, s[32:35], s86 offen offset:0 sc1
    buffer_load_dwordx4 a[196:199], v244, s[32:35], s86 offen offset:1024 sc1
    ds_read_b128 v[124:127], v21 offset:32768
    ds_read_b128 v[128:131], v246 offset:0
    ds_read_b128 v[132:135], v21 offset:33792
    ds_read_b128 v[136:139], v246 offset:1024
    ds_read_b128 v[140:143], v21 offset:34816
    ds_read_b128 v[144:147], v246 offset:2048
    ds_read_b128 v[148:151], v21 offset:35840
    ds_read_b128 v[152:155], v246 offset:3072
    s_waitcnt vmcnt(5) lgkmcnt(7)
    v_mfma_f32_32x32x16_bf16 v[76:91], v[124:127], a[176:179], 0
    s_waitcnt lgkmcnt(6)
    ds_read_b128 v[156:159], v21 offset:36864
    buffer_load_dwordx4 a[200:203], v244, s[32:35], s86 offen offset:2048 sc1
    v_mfma_f32_32x32x16_bf16 v[92:107], v[128:131], a[176:179], 0
    s_waitcnt vmcnt(5) lgkmcnt(6)
    ds_read_b128 v[160:163], v246 offset:4096
    ds_read_b32 v196, v247 offset:0
    buffer_load_dwordx4 a[204:207], v244, s[32:35], s86 offen offset:3072 sc1
    v_mfma_f32_32x32x16_bf16 v[76:91], v[132:135], a[180:183], v[76:91]
    s_waitcnt lgkmcnt(7)
    ds_read_b128 v[124:127], v21 offset:37888
    ds_read_b32 v197, v247 offset:128
    v_mfma_f32_32x32x16_bf16 v[92:107], v[136:139], a[180:183], v[92:107]
    s_waitcnt vmcnt(5) lgkmcnt(8)
    ds_read_b128 v[128:131], v246 offset:5120
    ds_read_b32 v198, v247 offset:256
    s_add_u32 s86, s86, 4096
    s_and_b32 s86, s86, 0x7fff
    buffer_load_dwordx4 a[208:211], v244, s[32:35], s86 offen offset:0 sc1
    v_mfma_f32_32x32x16_bf16 v[76:91], v[140:143], a[184:187], v[76:91]
    s_waitcnt lgkmcnt(9)
    ds_read_b128 v[132:135], v21 offset:38912
    ds_read_b32 v199, v247 offset:384
    v_mfma_f32_32x32x16_bf16 v[92:107], v[144:147], a[184:187], v[92:107]
    s_waitcnt vmcnt(5) lgkmcnt(10)
    ds_read_b128 v[136:139], v246 offset:6144
    ds_read_b32 v200, v247 offset:512
    buffer_load_dwordx4 a[212:215], v244, s[32:35], s86 offen offset:1024 sc1
    v_mfma_f32_32x32x16_bf16 v[76:91], v[148:151], a[188:191], v[76:91]
    s_waitcnt lgkmcnt(11)
    ds_read_b128 v[140:143], v21 offset:39936
    ds_read_b32 v201, v247 offset:640
    buffer_load_dwordx4 a[216:219], v244, s[32:35], s86 offen offset:2048 sc1
    v_mfma_f32_32x32x16_bf16 v[92:107], v[152:155], a[188:191], v[92:107]
    s_waitcnt vmcnt(6) lgkmcnt(12)
    ds_read_b128 v[144:147], v246 offset:7168
    v_mfma_f32_32x32x16_bf16 v[76:91], v[156:159], a[192:195], v[76:91]
    s_waitcnt lgkmcnt(12)
    ds_read_b128 v[148:151], v21 offset:40960
    buffer_load_dwordx4 a[220:223], v244, s[32:35], s86 offen offset:3072 sc1
    v_mfma_f32_32x32x16_bf16 v[92:107], v[160:163], a[192:195], v[92:107]
    s_waitcnt vmcnt(6) lgkmcnt(11)
    ds_read_b128 v[152:155], v246 offset:8192
    v_mfma_f32_32x32x16_bf16 v[76:91], v[124:127], a[196:199], v[76:91]
    s_waitcnt lgkmcnt(10)
    ds_read_b128 v[156:159], v21 offset:41984
    s_add_u32 s86, s86, 4096
    s_and_b32 s86, s86, 0x7fff
    buffer_load_dwordx4 a[224:227], v244, s[32:35], s86 offen offset:0 sc1
    s_waitcnt lgkmcnt(4)
    v_mfma_f32_32x32x16_bf16 v[92:107], v[128:131], a[196:199], v[92:107]
    s_waitcnt vmcnt(6)
    ds_read_b128 v[160:163], v246 offset:9216
    buffer_load_dwordx4 a[228:231], v244, s[32:35], s86 offen offset:1024 sc1
    v_cvt_pk_bf16_f32 v16, v196, v196
    v_and_b32 v17, 0xffff0000, v16
    v_sub_f32 v196, v196, v17
    v_mfma_f32_32x32x16_bf16 v[76:91], v[132:135], a[200:203], v[76:91]
    ds_read_b128 v[124:127], v21 offset:43008
    v_cvt_pk_bf16_f32 v17, v196, 0
    v_cvt_pk_bf16_f32 v14, v197, v197
    v_and_b32 v15, 0xffff0000, v14
    v_sub_f32 v197, v197, v15
    v_cvt_pk_bf16_f32 v15, v197, 0
    v_mfma_f32_32x32x16_bf16 v[92:107], v[136:139], a[200:203], v[92:107]
    s_waitcnt vmcnt(6)
    ds_read_b128 v[128:131], v246 offset:10240
    buffer_load_dwordx4 a[232:235], v244, s[32:35], s86 offen offset:2048 sc1
    v_cvt_pk_bf16_f32 v12, v198, v198
    v_and_b32 v13, 0xffff0000, v12
    v_sub_f32 v198, v198, v13
    v_mfma_f32_32x32x16_bf16 v[76:91], v[140:143], a[204:207], v[76:91]
    s_waitcnt lgkmcnt(6)
    ds_read_b128 v[132:135], v21 offset:44032
    v_cvt_pk_bf16_f32 v13, v198, 0
    v_cvt_pk_bf16_f32 v10, v199, v199
    v_and_b32 v11, 0xffff0000, v10
    v_sub_f32 v199, v199, v11
    v_cvt_pk_bf16_f32 v11, v199, 0
    v_mfma_f32_32x32x16_bf16 v[92:107], v[144:147], a[204:207], v[92:107]
    s_waitcnt vmcnt(6) lgkmcnt(6)
    ds_read_b128 v[136:139], v246 offset:11264
    buffer_load_dwordx4 a[236:239], v244, s[32:35], s86 offen offset:3072 sc1
    v_cvt_pk_bf16_f32 v8, v200, v200
    v_and_b32 v9, 0xffff0000, v8
    v_sub_f32 v200, v200, v9
    v_mfma_f32_32x32x16_bf16 v[76:91], v[148:151], a[208:211], v[76:91]
    s_waitcnt lgkmcnt(6)
    ds_read_b128 v[140:143], v21 offset:45056
    v_cvt_pk_bf16_f32 v9, v200, 0
    v_cvt_pk_bf16_f32 v6, v201, v201
    v_and_b32 v7, 0xffff0000, v6
    v_sub_f32 v201, v201, v7
    v_cvt_pk_bf16_f32 v7, v201, 0
    v_mfma_f32_32x32x16_bf16 v[92:107], v[152:155], a[208:211], v[92:107]
    s_waitcnt vmcnt(6) lgkmcnt(6)
    ds_read_b128 v[144:147], v246 offset:12288
    s_add_u32 s86, s86, 4096
    s_and_b32 s86, s86, 0x7fff
    buffer_load_dwordx4 a[240:243], v244, s[32:35], s86 offen offset:0 sc1
    v_mov_b32 v18, 0
    v_mfma_f32_32x32x16_bf16 v[76:91], v[156:159], a[212:215], v[76:91]
    s_waitcnt lgkmcnt(6)
    ds_read_b128 v[148:151], v21 offset:46080
    buffer_load_dwordx4 a[244:247], v244, s[32:35], s86 offen offset:1024 sc1
    v_mov_b32 v19, 0
    v_mov_b32 v206, 0
    v_mov_b32 v207, 0
    v_mfma_f32_32x32x16_bf16 v[92:107], v[160:163], a[212:215], v[92:107]
    s_waitcnt vmcnt(7) lgkmcnt(6)
    ds_read_b128 v[152:155], v246 offset:13312
    v_mfma_f32_32x32x16_bf16 v[76:91], v[124:127], a[216:219], v[76:91]
    s_waitcnt lgkmcnt(6)
    ds_read_b128 v[156:159], v21 offset:47104
    buffer_load_dwordx4 a[248:251], v244, s[32:35], s86 offen offset:2048 sc1
    v_mfma_f32_32x32x16_bf16 v[92:107], v[128:131], a[216:219], v[92:107]
    s_waitcnt vmcnt(7) lgkmcnt(6)
    ds_read_b128 v[160:163], v246 offset:14336
    v_mfma_f32_32x32x16_bf16 v[76:91], v[132:135], a[220:223], v[76:91]
    s_waitcnt lgkmcnt(6)
    ds_read_b128 v[124:127], v21 offset:48128
    buffer_load_dwordx4 a[252:255], v244, s[32:35], s86 offen offset:3072 sc1
    v_mfma_f32_32x32x16_bf16 v[92:107], v[136:139], a[220:223], v[92:107]
    s_waitcnt vmcnt(7) lgkmcnt(6)
    ds_read_b128 v[128:131], v246 offset:15360
    s_add_u32 s86, s86, 4096
    s_and_b32 s86, s86, 0x7fff
    buffer_load_dwordx4 v[28:31], v244, s[32:35], s86 offen offset:0 sc1
    v_mfma_f32_32x32x16_bf16 v[76:91], v[140:143], a[224:227], v[76:91]
    s_waitcnt lgkmcnt(6)
    ds_read_b128 v[132:135], v21 offset:49152
    v_mfma_f32_32x32x16_bf16 v[92:107], v[144:147], a[224:227], v[92:107]
    s_waitcnt vmcnt(7) lgkmcnt(6)
    ds_read_b128 v[136:139], v246 offset:16384
    buffer_load_dwordx4 v[32:35], v244, s[32:35], s86 offen offset:1024 sc1
    v_mfma_f32_32x32x16_bf16 v[76:91], v[148:151], a[228:231], v[76:91]
    s_waitcnt lgkmcnt(6)
    ds_read_b128 v[140:143], v21 offset:50176
    v_mfma_f32_32x32x16_bf16 v[92:107], v[152:155], a[228:231], v[92:107]
    s_waitcnt vmcnt(7) lgkmcnt(6)
    ds_read_b128 v[144:147], v246 offset:17408
    buffer_load_dwordx4 v[36:39], v244, s[32:35], s86 offen offset:2048 sc1
    v_mfma_f32_32x32x16_bf16 v[76:91], v[156:159], a[232:235], v[76:91]
    s_waitcnt lgkmcnt(6)
    ds_read_b128 v[148:151], v21 offset:51200
    buffer_load_dwordx4 v[40:43], v244, s[32:35], s86 offen offset:3072 sc1
    v_mfma_f32_32x32x16_bf16 v[92:107], v[160:163], a[232:235], v[92:107]
    s_waitcnt vmcnt(8) lgkmcnt(6)
    ds_read_b128 v[152:155], v246 offset:18432
    v_mfma_f32_32x32x16_bf16 v[76:91], v[124:127], a[236:239], v[76:91]
    s_waitcnt lgkmcnt(6)
    ds_read_b128 v[156:159], v21 offset:52224
    s_add_u32 s86, s86, 4096
    s_and_b32 s86, s86, 0x7fff
    buffer_load_dwordx4 v[44:47], v244, s[32:35], s86 offen offset:0 sc1
    v_mfma_f32_32x32x16_bf16 v[92:107], v[128:131], a[236:239], v[92:107]
    s_waitcnt vmcnt(8) lgkmcnt(6)
    ds_read_b128 v[160:163], v246 offset:19456
    v_mfma_f32_32x32x16_bf16 v[76:91], v[132:135], a[240:243], v[76:91]
    s_waitcnt lgkmcnt(6)
    ds_read_b128 v[124:127], v21 offset:53248
    buffer_load_dwordx4 v[48:51], v244, s[32:35], s86 offen offset:1024 sc1
    v_mfma_f32_32x32x16_bf16 v[92:107], v[136:139], a[240:243], v[92:107]
    s_waitcnt vmcnt(8) lgkmcnt(6)
    ds_read_b128 v[128:131], v246 offset:20480
    v_mfma_f32_32x32x16_bf16 v[76:91], v[140:143], a[244:247], v[76:91]
    s_waitcnt lgkmcnt(6)
    ds_read_b128 v[132:135], v21 offset:54272
    buffer_load_dwordx4 v[52:55], v244, s[32:35], s86 offen offset:2048 sc1
    v_mfma_f32_32x32x16_bf16 v[92:107], v[144:147], a[244:247], v[92:107]
    s_waitcnt vmcnt(8) lgkmcnt(6)
    ds_read_b128 v[136:139], v246 offset:21504
    buffer_load_dwordx4 v[56:59], v244, s[32:35], s86 offen offset:3072 sc1
    v_mfma_f32_32x32x16_bf16 v[76:91], v[148:151], a[248:251], v[76:91]
    s_waitcnt lgkmcnt(6)
    ds_read_b128 v[140:143], v21 offset:55296
    v_mfma_f32_32x32x16_bf16 v[92:107], v[152:155], a[248:251], v[92:107]
    s_waitcnt vmcnt(8) lgkmcnt(6)
    ds_read_b128 v[144:147], v246 offset:22528
    s_add_u32 s86, s86, 4096
    s_and_b32 s86, s86, 0x7fff
    buffer_load_dwordx4 v[60:63], v244, s[32:35], s86 offen offset:0 sc1
    v_mfma_f32_32x32x16_bf16 v[76:91], v[156:159], a[252:255], v[76:91]
    s_waitcnt lgkmcnt(6)
    ds_read_b128 v[148:151], v21 offset:56320
    v_mfma_f32_32x32x16_bf16 v[92:107], v[160:163], a[252:255], v[92:107]
    s_waitcnt vmcnt(8) lgkmcnt(6)
    ds_read_b128 v[152:155], v246 offset:23552
    buffer_load_dwordx4 v[64:67], v244, s[32:35], s86 offen offset:1024 sc1
    v_mfma_f32_32x32x16_bf16 v[76:91], v[124:127], v[28:31], v[76:91]
    s_waitcnt lgkmcnt(6)
    ds_read_b128 v[156:159], v21 offset:57344
    buffer_load_dwordx4 v[68:71], v244, s[32:35], s86 offen offset:2048 sc1
    v_mfma_f32_32x32x16_bf16 v[92:107], v[128:131], v[28:31], v[92:107]
    s_waitcnt vmcnt(9) lgkmcnt(6)
    ds_read_b128 v[160:163], v246 offset:24576
    v_mfma_f32_32x32x16_bf16 v[76:91], v[132:135], v[32:35], v[76:91]
    s_waitcnt lgkmcnt(6)
    ds_read_b128 v[124:127], v21 offset:58368
    buffer_load_dwordx4 v[72:75], v244, s[32:35], s86 offen offset:3072 sc1
    v_mfma_f32_32x32x16_bf16 v[92:107], v[136:139], v[32:35], v[92:107]
    s_waitcnt vmcnt(9) lgkmcnt(6)
    ds_read_b128 v[128:131], v246 offset:25600
    v_mfma_f32_32x32x16_bf16 v[76:91], v[140:143], v[36:39], v[76:91]
    s_waitcnt lgkmcnt(6)
    ds_read_b128 v[132:135], v21 offset:59392
    buffer_load_dword v180, v22, s[32:35], s87 offen offset:0 sc1
    v_mfma_f32_32x32x16_bf16 v[92:107], v[144:147], v[36:39], v[92:107]
    s_waitcnt vmcnt(9) lgkmcnt(6)
    ds_read_b128 v[136:139], v246 offset:26624
    buffer_load_dword v181, v22, s[32:35], s87 offen offset:256 sc1
    v_mfma_f32_32x32x16_bf16 v[76:91], v[148:151], v[40:43], v[76:91]
    s_waitcnt lgkmcnt(6)
    ds_read_b128 v[140:143], v21 offset:60416
    buffer_load_dword v182, v22, s[32:35], s87 offen offset:512 sc1
    v_mfma_f32_32x32x16_bf16 v[92:107], v[152:155], v[40:43], v[92:107]
    s_waitcnt vmcnt(10) lgkmcnt(6)
    ds_read_b128 v[144:147], v246 offset:27648
    buffer_load_dword v183, v22, s[32:35], s87 offen offset:768 sc1
    v_mfma_f32_32x32x16_bf16 v[76:91], v[156:159], v[44:47], v[76:91]
    s_waitcnt lgkmcnt(6)
    ds_read_b128 v[148:151], v21 offset:61440
    buffer_load_dword v184, v22, s[32:35], s87 offen offset:1024 sc1
    v_mfma_f32_32x32x16_bf16 v[92:107], v[160:163], v[44:47], v[92:107]
    s_waitcnt vmcnt(11) lgkmcnt(6)
    ds_read_b128 v[152:155], v246 offset:28672
    buffer_load_dword v185, v22, s[32:35], s87 offen offset:1280 sc1
    v_mfma_f32_32x32x16_bf16 v[76:91], v[124:127], v[48:51], v[76:91]
    s_waitcnt lgkmcnt(6)
    ds_read_b128 v[156:159], v21 offset:62464
    buffer_load_dword v186, v22, s[32:35], s87 offen offset:1536 sc1
    v_mfma_f32_32x32x16_bf16 v[92:107], v[128:131], v[48:51], v[92:107]
    s_waitcnt vmcnt(12) lgkmcnt(6)
    ds_read_b128 v[160:163], v246 offset:29696
    buffer_load_dword v187, v22, s[32:35], s87 offen offset:1792 sc1
    v_mfma_f32_32x32x16_bf16 v[76:91], v[132:135], v[52:55], v[76:91]
    s_waitcnt lgkmcnt(6)
    ds_read_b128 v[124:127], v21 offset:63488
    buffer_load_dword v188, v22, s[32:35], s87 offen offset:2048 sc1
    v_mfma_f32_32x32x16_bf16 v[92:107], v[136:139], v[52:55], v[92:107]
    s_waitcnt vmcnt(13) lgkmcnt(6)
    ds_read_b128 v[128:131], v246 offset:30720
    buffer_load_dword v189, v22, s[32:35], s87 offen offset:2304 sc1
    v_mfma_f32_32x32x16_bf16 v[76:91], v[140:143], v[56:59], v[76:91]
    s_waitcnt lgkmcnt(6)
    ds_read_b128 v[132:135], v21 offset:64512
    buffer_load_dword v190, v22, s[32:35], s87 offen offset:2560 sc1
    v_mfma_f32_32x32x16_bf16 v[92:107], v[144:147], v[56:59], v[92:107]
    s_waitcnt vmcnt(14) lgkmcnt(6)
    ds_read_b128 v[136:139], v246 offset:31744
    buffer_load_dword v191, v22, s[32:35], s87 offen offset:2816 sc1
    v_mfma_f32_32x32x16_bf16 v[76:91], v[148:151], v[60:63], v[76:91]
    s_waitcnt lgkmcnt(6)
    ds_read_b128 v[140:143], v246 offset:32768
    buffer_load_dword v192, v22, s[32:35], s87 offen offset:3072 sc1
    v_mfma_f32_32x32x16_bf16 v[92:107], v[152:155], v[60:63], v[92:107]
    s_waitcnt vmcnt(15) lgkmcnt(6)
    ds_read_b128 v[144:147], v246 offset:33792
    buffer_load_dword v193, v22, s[32:35], s87 offen offset:3328 sc1
    v_mfma_f32_32x32x16_bf16 v[76:91], v[156:159], v[64:67], v[76:91]
    s_waitcnt lgkmcnt(6)
    ds_read_b128 v[148:151], v246 offset:34816
    buffer_load_dword v194, v22, s[32:35], s87 offen offset:3584 sc1
    v_mfma_f32_32x32x16_bf16 v[92:107], v[160:163], v[64:67], v[92:107]
    s_waitcnt vmcnt(16) lgkmcnt(6)
    ds_read_b128 v[152:155], v246 offset:35840
    buffer_load_dword v195, v22, s[32:35], s87 offen offset:3840 sc1
    v_mfma_f32_32x32x16_bf16 v[76:91], v[124:127], v[68:71], v[76:91]
    s_waitcnt lgkmcnt(6)
    ds_read_b128 v[156:159], v246 offset:36864
    s_add_u32 m0, s19, 0
    s_add_u32 s9, s18, 98304
    buffer_load_dwordx4 v248, s[32:35], s9 offen offset:0 sc1 lds
    v_mfma_f32_32x32x16_bf16 v[92:107], v[128:131], v[68:71], v[92:107]
    s_waitcnt vmcnt(17) lgkmcnt(6)
    ds_read_b128 v[160:163], v246 offset:37888
    buffer_load_dwordx4 v248, s[32:35], s9 offen offset:1024 sc1 lds
    v_mfma_f32_32x32x16_bf16 v[76:91], v[132:135], v[72:75], v[76:91]
    s_waitcnt lgkmcnt(6)
    ds_read_b128 v[124:127], v246 offset:38912
    buffer_load_dwordx4 v248, s[32:35], s9 offen offset:2048 sc1 lds
    v_mfma_f32_32x32x16_bf16 v[92:107], v[136:139], v[72:75], v[92:107]
    ds_read_b128 v[128:131], v246 offset:39936
    buffer_load_dwordx4 v248, s[32:35], s9 offen offset:3072 sc1 lds
    s_add_u32 m0, s19, 4096
    s_nop 0
    buffer_load_dwordx4 v251, s[32:35], s9 offen offset:0 sc1 lds
    buffer_load_dwordx4 v251, s[32:35], s9 offen offset:1024 sc1 lds
    buffer_load_dwordx4 v251, s[32:35], s9 offen offset:2048 sc1 lds
    buffer_load_dwordx4 v251, s[32:35], s9 offen offset:3072 sc1 lds
    s_barrier
    s_lshl_b32 s72, s68, 7
    s_add_u32 s84, s72, 53248
    s_lshr_b32 s74, s66, 1
    s_lshl_b32 s74, s74, 7
    s_add_u32 s85, s74, 53248
    s_add_u32 s87, s85, 2048
    s_waitcnt lgkmcnt(7)
    v_mfma_f32_32x32x16_bf16 v[108:123], v[140:143], a[176:179], 0
    s_waitcnt lgkmcnt(6)
    ds_read_b128 v[132:135], v246 offset:40960
    s_add_u32 m0, s19, 32768
    s_add_u32 s9, s18, 131072
    buffer_load_dwordx4 v248, s[32:35], s9 offen offset:0 sc1 lds
    s_waitcnt vmcnt(9)
    v_mfma_f32_32x32x16_bf16 v[108:123], v[144:147], a[180:183], v[108:123]
    s_waitcnt lgkmcnt(6)
    ds_read_b128 v[136:139], v246 offset:41984
    v_add_f32 v180, v180, v188
    v_add_f32 v181, v181, v189
    v_add_f32 v182, v182, v190
    v_add_f32 v183, v183, v191
    v_add_f32 v184, v184, v192
    v_mfma_f32_32x32x16_bf16 v[108:123], v[148:151], a[184:187], v[108:123]
    s_waitcnt lgkmcnt(6)
    ds_read_b128 v[140:143], v246 offset:43008
    buffer_load_dwordx4 v248, s[32:35], s9 offen offset:1024 sc1 lds
    v_add_f32 v185, v185, v193
    v_add_f32 v186, v186, v194
    v_add_f32 v187, v187, v195
    v_mfma_f32_32x32x16_bf16 v[108:123], v[152:155], a[188:191], v[108:123]
    s_waitcnt lgkmcnt(6)
    ds_read_b128 v[144:147], v246 offset:44032
    v_add_f32 v180, v180, v184
    v_add_f32 v181, v181, v185
    v_add_f32 v182, v182, v186
    v_add_f32 v183, v183, v187
    v_add_f32 v180, v180, v182
    v_mfma_f32_32x32x16_bf16 v[108:123], v[156:159], a[192:195], v[108:123]
    s_waitcnt lgkmcnt(6)
    ds_read_b128 v[148:151], v246 offset:45056
    buffer_load_dwordx4 v248, s[32:35], s9 offen offset:2048 sc1 lds
    v_add_f32 v181, v181, v183
    v_add_f32 v180, v180, v181
    v_mov_b32 v181, v180
    v_mfma_f32_32x32x16_bf16 v[108:123], v[160:163], a[196:199], v[108:123]
    s_waitcnt lgkmcnt(6)
    ds_read_b128 v[152:155], v246 offset:46080
    v_cmp_gt_u32 vcc, 32, v1
    v_mov_b32 v184, 0
    v_permlane32_swap_b32 v180, v181
    v_mul_f32 v228, 0xbb000000, v180
    v_mul_f32 v181, 0x3b000000, v181
    v_mfma_f32_32x32x16_bf16 v[108:123], v[124:127], a[200:203], v[108:123]
    s_waitcnt lgkmcnt(6)
    ds_read_b128 v[156:159], v246 offset:47104
    v_cndmask_b32 v184, v184, v228, vcc
    v_fma_f32 v231, -v228, v228, v181
    v_cvt_pk_bf16_f32 v205, v184, 0
    v_max_f32 v231, 0, v231
    v_lshlrev_b32 v185, 16, v205
    v_mfma_f32_32x32x16_bf16 v[108:123], v[128:131], a[204:207], v[108:123]
    s_waitcnt lgkmcnt(6)
    ds_read_b128 v[160:163], v246 offset:48128
    buffer_load_dwordx4 v248, s[32:35], s9 offen offset:3072 sc1 lds
    v_add_f32 v231, 0x3727c5ac, v231
    v_sub_f32 v185, v184, v185
    v_mfma_f32_32x32x16_bf16 v[108:123], v[132:135], a[208:211], v[108:123]
    s_waitcnt lgkmcnt(6)
    ds_read_b128 v[124:127], v246 offset:49152
    v_rsq_f32 v183, v231
    v_cvt_pk_bf16_f32 v204, v184, v185
    v_mul_f32 v229, 0xc0135761, v183
    v_mul_f32 v183, v183, v183
    v_mfma_f32_32x32x16_bf16 v[108:123], v[136:139], a[212:215], v[108:123]
    s_add_u32 m0, s19, 36864
    ds_read_b128 v[128:131], v246 offset:50176
    buffer_load_dwordx4 v251, s[32:35], s9 offen offset:0 sc1 lds
    v_mul_f32 v183, 0x3d372713, v183
    v_mul_f32 v230, v229, v183
    v_mfma_f32_32x32x16_bf16 v[76:91], v[16:19], v[204:207], v[76:91]
    v_mfma_f32_32x32x16_bf16 v[92:107], v[14:17], v[204:207], v[92:107]
    s_waitcnt lgkmcnt(7)
    v_mfma_f32_32x32x16_bf16 v[108:123], v[140:143], a[216:219], v[108:123]
    s_waitcnt lgkmcnt(6)
    ds_read_b128 v[132:135], v246 offset:51200
    buffer_load_dwordx4 v251, s[32:35], s9 offen offset:1024 sc1 lds
    s_nop 5
    v_mul_f32 v196, v76, v76
    v_mul_f32 v197, v77, v77
    v_mul_f32 v198, v78, v78
    v_mfma_f32_32x32x16_bf16 v[108:123], v[144:147], a[220:223], v[108:123]
    s_waitcnt lgkmcnt(6)
    ds_read_b128 v[136:139], v246 offset:52224
    v_mul_f32 v199, v79, v79
    v_mul_f32 v200, v84, v84
    v_mul_f32 v201, v85, v85
    v_mul_f32 v202, v86, v86
    v_mul_f32 v203, v87, v87
    v_mfma_f32_32x32x16_bf16 v[108:123], v[148:151], a[224:227], v[108:123]
    s_waitcnt lgkmcnt(6)
    ds_read_b128 v[140:143], v246 offset:53248
    buffer_load_dwordx4 v251, s[32:35], s9 offen offset:2048 sc1 lds
    v_fma_f32 v196, v196, v230, v229
    v_fma_f32 v197, v197, v230, v229
    v_fma_f32 v198, v198, v230, v229
    v_mfma_f32_32x32x16_bf16 v[108:123], v[152:155], a[228:231], v[108:123]
    s_waitcnt lgkmcnt(6)
    ds_read_b128 v[144:147], v246 offset:54272
    v_fma_f32 v199, v199, v230, v229
    v_fma_f32 v200, v200, v230, v229
    v_fma_f32 v201, v201, v230, v229
    v_fma_f32 v202, v202, v230, v229
    v_fma_f32 v203, v203, v230, v229
    v_mfma_f32_32x32x16_bf16 v[108:123], v[156:159], a[232:235], v[108:123]
    s_waitcnt lgkmcnt(6)
    ds_read_b128 v[148:151], v246 offset:55296
    buffer_load_dwordx4 v251, s[32:35], s9 offen offset:3072 sc1 lds
    v_mul_f32 v196, v196, v76
    v_mul_f32 v197, v197, v77
    v_mul_f32 v198, v198, v78
    v_mfma_f32_32x32x16_bf16 v[108:123], v[160:163], a[236:239], v[108:123]
    s_waitcnt lgkmcnt(6)
    ds_read_b128 v[152:155], v246 offset:56320
    v_mul_f32 v199, v199, v79
    v_mul_f32 v200, v200, v84
    v_mul_f32 v201, v201, v85
    v_mul_f32 v202, v202, v86
    v_mul_f32 v203, v203, v87
    v_mfma_f32_32x32x16_bf16 v[108:123], v[124:127], a[240:243], v[108:123]
    s_waitcnt lgkmcnt(6)
    ds_read_b128 v[156:159], v246 offset:57344
    v_exp_f32 v196, v196
    v_mul_f32 v76, v76, v80
    v_exp_f32 v197, v197
    v_mfma_f32_32x32x16_bf16 v[108:123], v[128:131], a[244:247], v[108:123]
    s_waitcnt lgkmcnt(6)
    ds_read_b128 v[160:163], v246 offset:58368
    s_cmp_lt_u32 s80, 6
    s_cbranch_scc1 L_sk_26
    s_add_u32 m0, s19, 65536
    s_add_u32 s9, s18, 163840
    buffer_load_dwordx4 v248, s[32:35], s9 offen offset:0 sc1 lds
    buffer_load_dwordx4 v248, s[32:35], s9 offen offset:1024 sc1 lds
L_sk_26:
    v_mul_f32 v77, v77, v81
    v_exp_f32 v198, v198
    v_mfma_f32_32x32x16_bf16 v[108:123], v[132:135], a[248:251], v[108:123]
    s_waitcnt lgkmcnt(6)
    ds_read_b128 v[124:127], v246 offset:59392
    v_mul_f32 v78, v78, v82
    v_exp_f32 v199, v199
    v_mul_f32 v79, v79, v83
    v_mfma_f32_32x32x16_bf16 v[108:123], v[136:139], a[252:255], v[108:123]
    s_waitcnt lgkmcnt(6)
    ds_read_b128 v[128:131], v246 offset:60416
    v_exp_f32 v200, v200
    v_mul_f32 v84, v84, v88
    v_exp_f32 v201, v201
    v_mfma_f32_32x32x16_bf16 v[108:123], v[140:143], v[28:31], v[108:123]
    s_waitcnt lgkmcnt(6)
    ds_read_b128 v[132:135], v246 offset:61440
    v_mul_f32 v85, v85, v89
    v_exp_f32 v202, v202
    v_mul_f32 v86, v86, v90
    v_mfma_f32_32x32x16_bf16 v[108:123], v[144:147], v[32:35], v[108:123]
    s_waitcnt lgkmcnt(6)
    ds_read_b128 v[136:139], v246 offset:62464
    v_exp_f32 v203, v203
    v_mul_f32 v87, v87, v91
    v_fma_f32 v196, v196, v231, v231
    v_fma_f32 v197, v197, v231, v231
    v_mfma_f32_32x32x16_bf16 v[108:123], v[148:151], v[36:39], v[108:123]
    s_waitcnt lgkmcnt(6)
    ds_read_b128 v[140:143], v246 offset:63488
    s_cmp_lt_u32 s80, 6
    s_cbranch_scc1 L_sk_27
    buffer_load_dwordx4 v248, s[32:35], s9 offen offset:2048 sc1 lds
    buffer_load_dwordx4 v248, s[32:35], s9 offen offset:3072 sc1 lds
L_sk_27:
    v_rcp_f32 v196, v196
    v_fma_f32 v198, v198, v231, v231
    v_mfma_f32_32x32x16_bf16 v[108:123], v[152:155], v[40:43], v[108:123]
    s_waitcnt vmcnt(8)
    s_barrier
    s_waitcnt lgkmcnt(6)
    ds_read_b128 v[144:147], v246 offset:64512
    v_rcp_f32 v197, v197
    v_fma_f32 v199, v199, v231, v231
    v_mfma_f32_32x32x16_bf16 v[108:123], v[156:159], v[44:47], v[108:123]
    s_waitcnt lgkmcnt(6)
    ds_read_b128 v[148:151], v21 offset:0
    v_rcp_f32 v198, v198
    v_fma_f32 v200, v200, v231, v231
    v_rcp_f32 v199, v199
    v_mfma_f32_32x32x16_bf16 v[108:123], v[160:163], v[48:51], v[108:123]
    s_waitcnt lgkmcnt(6)
    ds_read_b128 v[152:155], v21 offset:1024
    v_fma_f32 v201, v201, v231, v231
    v_rcp_f32 v200, v200
    v_fma_f32 v202, v202, v231, v231
    v_mfma_f32_32x32x16_bf16 v[108:123], v[124:127], v[52:55], v[108:123]
    s_waitcnt lgkmcnt(6)
    ds_read_b128 v[156:159], v21 offset:2048
    s_cmp_lt_u32 s80, 6
    s_cbranch_scc1 L_sk_28
    s_add_u32 m0, s19, 69632
    s_nop 0
    buffer_load_dwordx4 v251, s[32:35], s9 offen offset:0 sc1 lds
    buffer_load_dwordx4 v251, s[32:35], s9 offen offset:1024 sc1 lds
L_sk_28:
    v_rcp_f32 v201, v201
    v_fma_f32 v203, v203, v231, v231
    v_mfma_f32_32x32x16_bf16 v[108:123], v[128:131], v[56:59], v[108:123]
    s_waitcnt lgkmcnt(6)
    ds_read_b128 v[160:163], v21 offset:3072
    v_rcp_f32 v202, v202
    v_rcp_f32 v203, v203
    v_mul_f32 v76, v76, v196
    v_mfma_f32_32x32x16_bf16 v[108:123], v[132:135], v[60:63], v[108:123]
    s_waitcnt lgkmcnt(6)
    ds_read_b128 v[124:127], v21 offset:4096
    v_mul_f32 v77, v77, v197
    v_mul_f32 v78, v78, v198
    v_mul_f32 v79, v79, v199
    v_mul_f32 v84, v84, v200
    v_mul_f32 v85, v85, v201
    v_mfma_f32_32x32x16_bf16 v[108:123], v[136:139], v[64:67], v[108:123]
    s_waitcnt lgkmcnt(6)
    ds_read_b128 v[128:131], v21 offset:5120
    v_mul_f32 v86, v86, v202
    v_mul_f32 v87, v87, v203
    v_cvt_pk_bf16_f32 v220, v76, v77
    v_cvt_pk_bf16_f32 v221, v78, v79
    v_cvt_pk_bf16_f32 v222, v84, v85
    v_mfma_f32_32x32x16_bf16 v[108:123], v[140:143], v[68:71], v[108:123]
    s_waitcnt lgkmcnt(6)
    ds_read_b128 v[132:135], v21 offset:6144
    v_cvt_pk_bf16_f32 v223, v86, v87
    v_mfma_f32_32x32x16_bf16 v[108:123], v[144:147], v[72:75], v[108:123]
    ds_read_b128 v[136:139], v21 offset:7168
    buffer_store_dwordx4 v[220:223], v21, s[32:35], s16 offen offset:0 sc1
    s_cmp_lt_u32 s80, 6
    s_cbranch_scc1 L_sk_29
    buffer_load_dwordx4 v251, s[32:35], s9 offen offset:2048 sc1 lds
    buffer_load_dwordx4 v251, s[32:35], s9 offen offset:3072 sc1 lds
L_sk_29:
    v_mul_f32 v196, v92, v92
    v_mfma_f32_32x32x16_bf16 v[108:123], v[12:15], v[204:207], v[108:123]
    s_waitcnt lgkmcnt(7)
    v_mul_f32 v197, v93, v93
    v_mul_f32 v198, v94, v94
    v_mul_f32 v199, v95, v95
    v_mul_f32 v200, v100, v100
    v_mul_f32 v201, v101, v101
    v_mul_f32 v202, v102, v102
    v_mfma_f32_32x32x16_bf16 v[164:179], v[148:151], a[176:179], 0
    s_waitcnt lgkmcnt(6)
    ds_read_b128 v[140:143], v21 offset:8192
    v_mul_f32 v203, v103, v103
    v_fma_f32 v196, v196, v230, v229
    v_fma_f32 v197, v197, v230, v229
    v_fma_f32 v198, v198, v230, v229
    v_fma_f32 v199, v199, v230, v229
    v_mfma_f32_32x32x16_bf16 v[164:179], v[152:155], a[180:183], v[164:179]
    s_waitcnt lgkmcnt(6)
    ds_read_b128 v[144:147], v21 offset:9216
    v_fma_f32 v200, v200, v230, v229
    v_fma_f32 v201, v201, v230, v229
    v_fma_f32 v202, v202, v230, v229
    v_fma_f32 v203, v203, v230, v229
    v_mul_f32 v196, v196, v92
    v_mfma_f32_32x32x16_bf16 v[164:179], v[156:159], a[184:187], v[164:179]
    s_waitcnt lgkmcnt(6)
    ds_read_b128 v[148:151], v21 offset:10240
    v_mul_f32 v197, v197, v93
    v_mul_f32 v198, v198, v94
    v_mul_f32 v199, v199, v95
    v_mul_f32 v200, v200, v100
    v_mul_f32 v201, v201, v101
    v_mfma_f32_32x32x16_bf16 v[164:179], v[160:163], a[188:191], v[164:179]
    s_waitcnt lgkmcnt(6)
    ds_read_b128 v[152:155], v21 offset:11264
    s_add_u32 s20, s4, 0
    s_lshl_b32 s20, s20, 4
    buffer_load_dwordx4 a[0:3], v245, s[32:35], s20 offen sc1
    v_mul_f32 v202, v202, v102
    v_mfma_f32_32x32x16_bf16 v[164:179], v[124:127], a[192:195], v[164:179]
    s_waitcnt lgkmcnt(6)
    ds_read_b128 v[156:159], v21 offset:12288
    v_mul_f32 v203, v203, v103
    v_exp_f32 v196, v196
    v_mul_f32 v92, v92, v96
    v_mfma_f32_32x32x16_bf16 v[164:179], v[128:131], a[196:199], v[164:179]
    s_waitcnt lgkmcnt(6)
    ds_read_b128 v[160:163], v21 offset:13312
    buffer_load_dwordx4 a[4:7], v249, s[32:35], s20 offen sc1
    v_exp_f32 v197, v197
    v_mul_f32 v93, v93, v97
    v_mfma_f32_32x32x16_bf16 v[164:179], v[132:135], a[200:203], v[164:179]
    s_waitcnt lgkmcnt(6)
    ds_read_b128 v[124:127], v21 offset:14336
    v_exp_f32 v198, v198
    v_mul_f32 v94, v94, v98
    v_exp_f32 v199, v199
    v_mfma_f32_32x32x16_bf16 v[164:179], v[136:139], a[204:207], v[164:179]
    s_waitcnt lgkmcnt(6)
    ds_read_b128 v[128:131], v21 offset:15360
    v_mul_f32 v95, v95, v99
    v_exp_f32 v200, v200
    v_mul_f32 v100, v100, v104
    v_mfma_f32_32x32x16_bf16 v[164:179], v[140:143], a[208:211], v[164:179]
    s_waitcnt lgkmcnt(6)
    ds_read_b128 v[132:135], v21 offset:16384
    s_add_u32 s20, s4, 1024
    s_lshl_b32 s20, s20, 4
    buffer_load_dwordx4 a[8:11], v245, s[32:35], s20 offen sc1
    v_mfma_f32_32x32x16_bf16 v[164:179], v[144:147], a[212:215], v[164:179]
    s_waitcnt lgkmcnt(6)
    ds_read_b128 v[136:139], v21 offset:17408
    v_exp_f32 v201, v201
    v_mul_f32 v101, v101, v105
    v_exp_f32 v202, v202
    v_mfma_f32_32x32x16_bf16 v[164:179], v[148:151], a[216:219], v[164:179]
    s_waitcnt lgkmcnt(6)
    ds_read_b128 v[140:143], v21 offset:18432
    buffer_load_dwordx4 a[12:15], v249, s[32:35], s20 offen sc1
    v_mul_f32 v102, v102, v106
    v_exp_f32 v203, v203
    v_mfma_f32_32x32x16_bf16 v[164:179], v[152:155], a[220:223], v[164:179]
    s_waitcnt lgkmcnt(6)
    ds_read_b128 v[144:147], v21 offset:19456
    v_mul_f32 v103, v103, v107
    v_fma_f32 v196, v196, v231, v231
    v_fma_f32 v197, v197, v231, v231
    v_rcp_f32 v196, v196
    v_mfma_f32_32x32x16_bf16 v[164:179], v[156:159], a[224:227], v[164:179]
    s_waitcnt lgkmcnt(6)
    ds_read_b128 v[148:151], v21 offset:20480
    v_fma_f32 v198, v198, v231, v231
    v_rcp_f32 v197, v197
    v_fma_f32 v199, v199, v231, v231
    v_mfma_f32_32x32x16_bf16 v[164:179], v[160:163], a[228:231], v[164:179]
    s_waitcnt lgkmcnt(6)
    ds_read_b128 v[152:155], v21 offset:21504
    s_add_u32 s20, s4, 2048
    s_lshl_b32 s20, s20, 4
    buffer_load_dwordx4 a[16:19], v245, s[32:35], s20 offen sc1
    v_mfma_f32_32x32x16_bf16 v[164:179], v[124:127], a[232:235], v[164:179]
    s_waitcnt lgkmcnt(6)
    ds_read_b128 v[156:159], v21 offset:22528
    v_rcp_f32 v198, v198
    v_fma_f32 v200, v200, v231, v231
    v_rcp_f32 v199, v199
    v_mfma_f32_32x32x16_bf16 v[164:179], v[128:131], a[236:239], v[164:179]
    s_waitcnt lgkmcnt(6)
    ds_read_b128 v[160:163], v21 offset:23552
    buffer_load_dwordx4 a[20:23], v249, s[32:35], s20 offen sc1
    v_fma_f32 v201, v201, v231, v231
    v_rcp_f32 v200, v200
    v_mfma_f32_32x32x16_bf16 v[164:179], v[132:135], a[240:243], v[164:179]
    s_waitcnt lgkmcnt(6)
    ds_read_b128 v[124:127], v21 offset:24576
    v_fma_f32 v202, v202, v231, v231
    v_rcp_f32 v201, v201
    v_fma_f32 v203, v203, v231, v231
    v_mfma_f32_32x32x16_bf16 v[164:179], v[136:139], a[244:247], v[164:179]
    s_waitcnt lgkmcnt(6)
    ds_read_b128 v[128:131], v21 offset:25600
    s_add_u32 s20, s5, 0
    s_lshl_b32 s20, s20, 4
    buffer_load_dwordx4 a[24:27], v245, s[32:35], s20 offen sc1
    v_mfma_f32_32x32x16_bf16 v[164:179], v[140:143], a[248:251], v[164:179]
    s_waitcnt lgkmcnt(6)
    ds_read_b128 v[132:135], v21 offset:26624
    v_rcp_f32 v202, v202
    v_rcp_f32 v203, v203
    v_mul_f32 v92, v92, v196
    v_mfma_f32_32x32x16_bf16 v[164:179], v[144:147], a[252:255], v[164:179]
    s_waitcnt lgkmcnt(6)
    ds_read_b128 v[136:139], v21 offset:27648
    v_mul_f32 v93, v93, v197
    v_mul_f32 v94, v94, v198
    v_mul_f32 v95, v95, v199
    v_mul_f32 v100, v100, v200
    v_mul_f32 v101, v101, v201
    v_mfma_f32_32x32x16_bf16 v[164:179], v[148:151], v[28:31], v[164:179]
    s_waitcnt lgkmcnt(6)
    ds_read_b128 v[140:143], v21 offset:28672
    buffer_load_dwordx4 a[28:31], v249, s[32:35], s20 offen sc1
    v_mul_f32 v102, v102, v202
    v_mul_f32 v103, v103, v203
    v_cvt_pk_bf16_f32 v224, v92, v93
    v_mfma_f32_32x32x16_bf16 v[164:179], v[152:155], v[32:35], v[164:179]
    s_waitcnt lgkmcnt(6)
    ds_read_b128 v[144:147], v21 offset:29696
    v_cvt_pk_bf16_f32 v225, v94, v95
    v_cvt_pk_bf16_f32 v226, v100, v101
    v_cvt_pk_bf16_f32 v227, v102, v103
    v_mfma_f32_32x32x16_bf16 v[164:179], v[156:159], v[36:39], v[164:179]
    s_waitcnt lgkmcnt(6)
    ds_read_b128 v[148:151], v21 offset:30720
    buffer_store_dwordx4 v[224:227], v21, s[32:35], s16 offen offset:1024 sc1
    s_add_u32 s20, s5, 1024
    s_lshl_b32 s20, s20, 4
    v_mul_f32 v196, v108, v108
    v_mfma_f32_32x32x16_bf16 v[164:179], v[160:163], v[40:43], v[164:179]
    s_waitcnt vmcnt(7)
    s_barrier
    s_waitcnt lgkmcnt(6)
    ds_read_b128 v[152:155], v21 offset:31744
    buffer_load_dwordx4 a[32:35], v245, s[32:35], s20 offen sc1
    v_mul_f32 v197, v109, v109
    v_mfma_f32_32x32x16_bf16 v[164:179], v[124:127], v[44:47], v[164:179]
    s_waitcnt lgkmcnt(6)
    ds_read_b128 v[156:159], v21 offset:32768
    v_mul_f32 v198, v110, v110
    v_mul_f32 v199, v111, v111
    v_mul_f32 v200, v116, v116
    v_mul_f32 v201, v117, v117
    v_mul_f32 v202, v118, v118
    v_mfma_f32_32x32x16_bf16 v[164:179], v[128:131], v[48:51], v[164:179]
    s_waitcnt lgkmcnt(6)
    ds_read_b128 v[160:163], v21 offset:33792
    buffer_load_dwordx4 a[36:39], v249, s[32:35], s20 offen sc1
    v_mul_f32 v203, v119, v119
    v_fma_f32 v196, v196, v230, v229
    v_fma_f32 v197, v197, v230, v229
    v_mfma_f32_32x32x16_bf16 v[164:179], v[132:135], v[52:55], v[164:179]
    s_waitcnt lgkmcnt(6)
    ds_read_b128 v[124:127], v21 offset:34816
    v_fma_f32 v198, v198, v230, v229
    v_fma_f32 v199, v199, v230, v229
    v_fma_f32 v200, v200, v230, v229
    v_fma_f32 v201, v201, v230, v229
    v_fma_f32 v202, v202, v230, v229
    v_mfma_f32_32x32x16_bf16 v[164:179], v[136:139], v[56:59], v[164:179]
    s_waitcnt lgkmcnt(6)
    ds_read_b128 v[128:131], v21 offset:35840
    s_add_u32 s20, s5, 2048
    s_lshl_b32 s20, s20, 4
    buffer_load_dwordx4 a[40:43], v245, s[32:35], s20 offen sc1
    v_fma_f32 v203, v203, v230, v229
    v_mfma_f32_32x32x16_bf16 v[164:179], v[140:143], v[60:63], v[164:179]
    s_waitcnt lgkmcnt(6)
    ds_read_b128 v[132:135], v21 offset:36864
    v_mul_f32 v196, v196, v108
    v_mul_f32 v197, v197, v109
    v_mul_f32 v198, v198, v110
    v_mul_f32 v199, v199, v111
    v_mul_f32 v200, v200, v116
    v_mfma_f32_32x32x16_bf16 v[164:179], v[144:147], v[64:67], v[164:179]
    s_waitcnt lgkmcnt(6)
    ds_read_b128 v[136:139], v21 offset:37888
    buffer_load_dwordx4 a[44:47], v249, s[32:35], s20 offen sc1
    v_mul_f32 v201, v201, v117
    v_mul_f32 v202, v202, v118
    v_mul_f32 v203, v203, v119
    v_mfma_f32_32x32x16_bf16 v[164:179], v[148:151], v[68:71], v[164:179]
    s_waitcnt lgkmcnt(6)
    ds_read_b128 v[140:143], v21 offset:38912
    v_exp_f32 v196, v196
    v_mul_f32 v108, v108, v112
    v_exp_f32 v197, v197
    v_mfma_f32_32x32x16_bf16 v[164:179], v[152:155], v[72:75], v[164:179]
    s_add_u32 s20, s6, 0
    ds_read_b128 v[144:147], v21 offset:39936
    v_mul_f32 v109, v109, v113
    v_exp_f32 v198, v198
    v_mul_f32 v110, v110, v114
    v_mfma_f32_32x32x16_bf16 v[164:179], v[10:13], v[204:207], v[164:179]
    s_waitcnt lgkmcnt(7)
    s_lshl_b32 s20, s20, 4
    buffer_load_dwordx4 a[48:51], v245, s[32:35], s20 offen sc1
    v_exp_f32 v199, v199
    v_mul_f32 v111, v111, v115
    v_mfma_f32_32x32x16_bf16 v[76:91], v[156:159], a[176:179], 0
    s_waitcnt lgkmcnt(6)
    ds_read_b128 v[148:151], v21 offset:40960
    v_exp_f32 v200, v200
    v_mul_f32 v116, v116, v120
    v_exp_f32 v201, v201
    v_mfma_f32_32x32x16_bf16 v[76:91], v[160:163], a[180:183], v[76:91]
    s_waitcnt lgkmcnt(6)
    ds_read_b128 v[152:155], v21 offset:41984
    buffer_load_dwordx4 a[52:55], v249, s[32:35], s20 offen sc1
    v_mul_f32 v117, v117, v121
    v_exp_f32 v202, v202
    v_mfma_f32_32x32x16_bf16 v[76:91], v[124:127], a[184:187], v[76:91]
    s_waitcnt lgkmcnt(6)
    ds_read_b128 v[156:159], v21 offset:43008
    v_mul_f32 v118, v118, v122
    v_exp_f32 v203, v203
    v_mul_f32 v119, v119, v123
    v_fma_f32 v196, v196, v231, v231
    v_mfma_f32_32x32x16_bf16 v[76:91], v[128:131], a[188:191], v[76:91]
    s_waitcnt lgkmcnt(6)
    ds_read_b128 v[160:163], v21 offset:44032
    v_fma_f32 v197, v197, v231, v231
    v_rcp_f32 v196, v196
    v_fma_f32 v198, v198, v231, v231
    v_mfma_f32_32x32x16_bf16 v[76:91], v[132:135], a[192:195], v[76:91]
    s_waitcnt lgkmcnt(6)
    ds_read_b128 v[124:127], v21 offset:45056
    s_add_u32 s20, s6, 1024
    s_lshl_b32 s20, s20, 4
    buffer_load_dwordx4 a[56:59], v245, s[32:35], s20 offen sc1
    v_mfma_f32_32x32x16_bf16 v[76:91], v[136:139], a[196:199], v[76:91]
    s_waitcnt lgkmcnt(6)
    ds_read_b128 v[128:131], v21 offset:46080
    v_rcp_f32 v197, v197
    v_fma_f32 v199, v199, v231, v231
    v_rcp_f32 v198, v198
    v_mfma_f32_32x32x16_bf16 v[76:91], v[140:143], a[200:203], v[76:91]
    s_waitcnt lgkmcnt(6)
    ds_read_b128 v[132:135], v21 offset:47104
    buffer_load_dwordx4 a[60:63], v249, s[32:35], s20 offen sc1
    v_fma_f32 v200, v200, v231, v231
    v_rcp_f32 v199, v199
    v_mfma_f32_32x32x16_bf16 v[76:91], v[144:147], a[204:207], v[76:91]
    s_waitcnt lgkmcnt(6)
    ds_read_b128 v[136:139], v21 offset:48128
    v_fma_f32 v201, v201, v231, v231
    v_rcp_f32 v200, v200
    v_fma_f32 v202, v202, v231, v231
    v_mfma_f32_32x32x16_bf16 v[76:91], v[148:151], a[208:211], v[76:91]
    s_waitcnt lgkmcnt(6)
    ds_read_b128 v[140:143], v21 offset:49152
    s_add_u32 s20, s6, 2048
    s_lshl_b32 s20, s20, 4
    buffer_load_dwordx4 a[64:67], v245, s[32:35], s20 offen sc1
    v_mfma_f32_32x32x16_bf16 v[76:91], v[152:155], a[212:215], v[76:91]
    s_waitcnt lgkmcnt(6)
    ds_read_b128 v[144:147], v21 offset:50176
    v_rcp_f32 v201, v201
    v_fma_f32 v203, v203, v231, v231
    v_rcp_f32 v202, v202
    v_mfma_f32_32x32x16_bf16 v[76:91], v[156:159], a[216:219], v[76:91]
    s_waitcnt lgkmcnt(6)
    ds_read_b128 v[148:151], v21 offset:51200
    v_rcp_f32 v203, v203
    v_mul_f32 v108, v108, v196
    v_mul_f32 v109, v109, v197
    v_mul_f32 v110, v110, v198
    v_mfma_f32_32x32x16_bf16 v[76:91], v[160:163], a[220:223], v[76:91]
    s_waitcnt lgkmcnt(6)
    ds_read_b128 v[152:155], v21 offset:52224
    buffer_load_dwordx4 a[68:71], v249, s[32:35], s20 offen sc1
    v_mul_f32 v111, v111, v199
    v_mul_f32 v116, v116, v200
    v_mul_f32 v117, v117, v201
    v_mfma_f32_32x32x16_bf16 v[76:91], v[124:127], a[224:227], v[76:91]
    s_waitcnt lgkmcnt(6)
    ds_read_b128 v[156:159], v21 offset:53248
    v_mul_f32 v118, v118, v202
    v_mul_f32 v119, v119, v203
    v_cvt_pk_bf16_f32 v220, v108, v109
    v_cvt_pk_bf16_f32 v221, v110, v111
    v_cvt_pk_bf16_f32 v222, v116, v117
    v_mfma_f32_32x32x16_bf16 v[76:91], v[128:131], a[228:231], v[76:91]
    s_waitcnt lgkmcnt(6)
    ds_read_b128 v[160:163], v21 offset:54272
    s_add_u32 s20, s7, 0
    s_lshl_b32 s20, s20, 4
    buffer_load_dwordx4 a[72:75], v245, s[32:35], s20 offen sc1
    v_cvt_pk_bf16_f32 v223, v118, v119
    v_mfma_f32_32x32x16_bf16 v[76:91], v[132:135], a[232:235], v[76:91]
    s_waitcnt lgkmcnt(6)
    ds_read_b128 v[124:127], v21 offset:55296
    buffer_store_dwordx4 v[220:223], v21, s[32:35], s16 offen offset:2048 sc1
    v_mul_f32 v196, v164, v164
    v_mul_f32 v197, v165, v165
    v_mul_f32 v198, v166, v166
    v_mfma_f32_32x32x16_bf16 v[76:91], v[136:139], a[236:239], v[76:91]
    s_waitcnt lgkmcnt(6)
    ds_read_b128 v[128:131], v21 offset:56320
    v_mul_f32 v199, v167, v167
    v_mul_f32 v200, v172, v172
    v_mul_f32 v201, v173, v173
    v_mul_f32 v202, v174, v174
    v_mul_f32 v203, v175, v175
    v_mfma_f32_32x32x16_bf16 v[76:91], v[140:143], a[240:243], v[76:91]
    s_waitcnt lgkmcnt(6)
    ds_read_b128 v[132:135], v21 offset:57344
    buffer_load_dwordx4 a[76:79], v249, s[32:35], s20 offen sc1
    v_fma_f32 v196, v196, v230, v229
    v_fma_f32 v197, v197, v230, v229
    v_fma_f32 v198, v198, v230, v229
    v_mfma_f32_32x32x16_bf16 v[76:91], v[144:147], a[244:247], v[76:91]
    s_waitcnt lgkmcnt(6)
    ds_read_b128 v[136:139], v21 offset:58368
    v_fma_f32 v199, v199, v230, v229
    v_fma_f32 v200, v200, v230, v229
    v_fma_f32 v201, v201, v230, v229
    v_fma_f32 v202, v202, v230, v229
    v_fma_f32 v203, v203, v230, v229
    v_mfma_f32_32x32x16_bf16 v[76:91], v[148:151], a[248:251], v[76:91]
    s_waitcnt lgkmcnt(6)
    ds_read_b128 v[140:143], v21 offset:59392
    s_add_u32 s20, s7, 1024
    s_lshl_b32 s20, s20, 4
    buffer_load_dwordx4 a[80:83], v245, s[32:35], s20 offen sc1
    v_mul_f32 v196, v196, v164
    v_mfma_f32_32x32x16_bf16 v[76:91], v[152:155], a[252:255], v[76:91]
    s_waitcnt lgkmcnt(6)
    ds_read_b128 v[144:147], v21 offset:60416
    v_mul_f32 v197, v197, v165
    v_mul_f32 v198, v198, v166
    v_mul_f32 v199, v199, v167
    v_mul_f32 v200, v200, v172
    v_mul_f32 v201, v201, v173
    v_mfma_f32_32x32x16_bf16 v[76:91], v[156:159], v[28:31], v[76:91]
    s_waitcnt lgkmcnt(6)
    ds_read_b128 v[148:151], v21 offset:61440
    buffer_load_dwordx4 a[84:87], v249, s[32:35], s20 offen sc1
    v_mul_f32 v202, v202, v174
    v_mul_f32 v203, v203, v175
    v_mfma_f32_32x32x16_bf16 v[76:91], v[160:163], v[32:35], v[76:91]
    s_waitcnt lgkmcnt(6)
    ds_read_b128 v[152:155], v21 offset:62464
    v_exp_f32 v196, v196
    v_mul_f32 v164, v164, v168
    v_exp_f32 v197, v197
    v_mfma_f32_32x32x16_bf16 v[76:91], v[124:127], v[36:39], v[76:91]
    s_waitcnt lgkmcnt(6)
    ds_read_b128 v[156:159], v21 offset:63488
    v_mul_f32 v165, v165, v169
    v_exp_f32 v198, v198
    v_mul_f32 v166, v166, v170
    v_mfma_f32_32x32x16_bf16 v[76:91], v[128:131], v[40:43], v[76:91]
    s_waitcnt lgkmcnt(6)
    ds_read_b128 v[160:163], v21 offset:64512
    s_add_u32 s20, s7, 2048
    s_lshl_b32 s20, s20, 4
    buffer_load_dwordx4 a[88:91], v245, s[32:35], s20 offen sc1
    v_mfma_f32_32x32x16_bf16 v[76:91], v[132:135], v[44:47], v[76:91]
    s_waitcnt lgkmcnt(6)
    ds_read_b128 v[124:127], v246 offset:0
    v_exp_f32 v199, v199
    v_mul_f32 v167, v167, v171
    v_exp_f32 v200, v200
    v_mfma_f32_32x32x16_bf16 v[76:91], v[136:139], v[48:51], v[76:91]
    s_waitcnt lgkmcnt(6)
    ds_read_b128 v[128:131], v246 offset:1024
    buffer_load_dwordx4 a[92:95], v249, s[32:35], s20 offen sc1
    v_mul_f32 v172, v172, v176
    v_exp_f32 v201, v201
    v_mfma_f32_32x32x16_bf16 v[76:91], v[140:143], v[52:55], v[76:91]
    s_waitcnt vmcnt(5)
    s_barrier
    s_cmp_lg_u32 s60, 0
    s_cbranch_scc1 L_sk_30
    s_mov_b64 exec, 1
    buffer_atomic_add v23, v242, s[32:35], s84 offen offset:0 sc1
    s_mov_b64 exec, -1
L_sk_30:
    s_waitcnt lgkmcnt(6)
    ds_read_b128 v[132:135], v246 offset:2048
    v_mul_f32 v173, v173, v177
    v_exp_f32 v202, v202
    v_mfma_f32_32x32x16_bf16 v[76:91], v[144:147], v[56:59], v[76:91]
    s_waitcnt lgkmcnt(6)
    ds_read_b128 v[136:139], v246 offset:3072
    v_mul_f32 v174, v174, v178
    v_exp_f32 v203, v203
    v_mul_f32 v175, v175, v179
    v_fma_f32 v196, v196, v231, v231
    v_mfma_f32_32x32x16_bf16 v[76:91], v[148:151], v[60:63], v[76:91]
    s_waitcnt lgkmcnt(6)
    ds_read_b128 v[140:143], v246 offset:4096
    s_add_u32 s20, s4, 3072
    s_lshl_b32 s20, s20, 4
    buffer_load_dwordx4 a[96:99], v245, s[32:35], s20 offen sc1
    v_fma_f32 v197, v197, v231, v231
    v_mfma_f32_32x32x16_bf16 v[76:91], v[152:155], v[64:67], v[76:91]
    s_waitcnt lgkmcnt(6)
    ds_read_b128 v[144:147], v246 offset:5120
    v_rcp_f32 v196, v196
    v_fma_f32 v198, v198, v231, v231
    v_rcp_f32 v197, v197
    v_mfma_f32_32x32x16_bf16 v[76:91], v[156:159], v[68:71], v[76:91]
    s_waitcnt lgkmcnt(6)
    ds_read_b128 v[148:151], v246 offset:6144
    buffer_load_dwordx4 a[100:103], v249, s[32:35], s20 offen sc1
    v_fma_f32 v199, v199, v231, v231
    v_rcp_f32 v198, v198
    v_mfma_f32_32x32x16_bf16 v[76:91], v[160:163], v[72:75], v[76:91]
    s_add_u32 s20, s4, 4096
    ds_read_b128 v[152:155], v246 offset:7168
    v_fma_f32 v200, v200, v231, v231
    v_rcp_f32 v199, v199
    v_fma_f32 v201, v201, v231, v231
    v_mfma_f32_32x32x16_bf16 v[76:91], v[8:11], v[204:207], v[76:91]
    s_lshl_b32 s20, s20, 4
    buffer_load_dwordx4 a[104:107], v245, s[32:35], s20 offen sc1
    v_rcp_f32 v200, v200
    v_fma_f32 v202, v202, v231, v231
    s_cmp_lt_u32 s80, 6
    s_cbranch_scc1 L_five_31
    s_waitcnt lgkmcnt(7)
    v_mfma_f32_32x32x16_bf16 v[92:107], v[124:127], a[176:179], 0
    s_waitcnt lgkmcnt(6)
    ds_read_b128 v[156:159], v246 offset:8192
    v_rcp_f32 v201, v201
    v_fma_f32 v203, v203, v231, v231
    v_rcp_f32 v202, v202
    v_mfma_f32_32x32x16_bf16 v[92:107], v[128:131], a[180:183], v[92:107]
    s_waitcnt lgkmcnt(6)
    ds_read_b128 v[160:163], v246 offset:9216
    v_rcp_f32 v203, v203
    v_mul_f32 v164, v164, v196
    v_mul_f32 v165, v165, v197
    v_mul_f32 v166, v166, v198
    v_mfma_f32_32x32x16_bf16 v[92:107], v[132:135], a[184:187], v[92:107]
    s_waitcnt lgkmcnt(6)
    ds_read_b128 v[124:127], v246 offset:10240
    buffer_load_dwordx4 a[108:111], v249, s[32:35], s20 offen sc1
    v_mul_f32 v167, v167, v199
    v_mul_f32 v172, v172, v200
    v_mul_f32 v173, v173, v201
    v_mfma_f32_32x32x16_bf16 v[92:107], v[136:139], a[188:191], v[92:107]
    s_waitcnt lgkmcnt(6)
    ds_read_b128 v[128:131], v246 offset:11264
    v_mul_f32 v174, v174, v202
    v_mul_f32 v175, v175, v203
    v_cvt_pk_bf16_f32 v224, v164, v165
    v_cvt_pk_bf16_f32 v225, v166, v167
    v_cvt_pk_bf16_f32 v226, v172, v173
    v_mfma_f32_32x32x16_bf16 v[92:107], v[140:143], a[192:195], v[92:107]
    s_waitcnt lgkmcnt(6)
    ds_read_b128 v[132:135], v246 offset:12288
    s_add_u32 s20, s5, 3072
    s_lshl_b32 s20, s20, 4
    buffer_load_dwordx4 a[112:115], v245, s[32:35], s20 offen sc1
    v_cvt_pk_bf16_f32 v227, v174, v175
    v_mfma_f32_32x32x16_bf16 v[92:107], v[144:147], a[196:199], v[92:107]
    s_waitcnt lgkmcnt(6)
    ds_read_b128 v[136:139], v246 offset:13312
    buffer_store_dwordx4 v[224:227], v21, s[32:35], s16 offen offset:3072 sc1
    v_mul_f32 v196, v76, v76
    v_mul_f32 v197, v77, v77
    v_mul_f32 v198, v78, v78
    v_mfma_f32_32x32x16_bf16 v[92:107], v[148:151], a[200:203], v[92:107]
    s_waitcnt lgkmcnt(6)
    ds_read_b128 v[140:143], v246 offset:14336
    v_mul_f32 v199, v79, v79
    v_mul_f32 v200, v84, v84
    v_mul_f32 v201, v85, v85
    v_mul_f32 v202, v86, v86
    v_mul_f32 v203, v87, v87
    v_mfma_f32_32x32x16_bf16 v[92:107], v[152:155], a[204:207], v[92:107]
    s_waitcnt lgkmcnt(6)
    ds_read_b128 v[144:147], v246 offset:15360
    buffer_load_dwordx4 a[116:119], v249, s[32:35], s20 offen sc1
    v_fma_f32 v196, v196, v230, v229
    v_fma_f32 v197, v197, v230, v229
    v_fma_f32 v198, v198, v230, v229
    v_mfma_f32_32x32x16_bf16 v[92:107], v[156:159], a[208:211], v[92:107]
    s_waitcnt lgkmcnt(6)
    ds_read_b128 v[148:151], v246 offset:16384
    v_fma_f32 v199, v199, v230, v229
    v_fma_f32 v200, v200, v230, v229
    v_fma_f32 v201, v201, v230, v229
    v_fma_f32 v202, v202, v230, v229
    v_fma_f32 v203, v203, v230, v229
    v_mfma_f32_32x32x16_bf16 v[92:107], v[160:163], a[212:215], v[92:107]
    s_waitcnt lgkmcnt(6)
    ds_read_b128 v[152:155], v246 offset:17408
    s_add_u32 s20, s5, 4096
    s_lshl_b32 s20, s20, 4
    buffer_load_dwordx4 a[120:123], v245, s[32:35], s20 offen sc1
    v_mul_f32 v196, v196, v76
    v_mfma_f32_32x32x16_bf16 v[92:107], v[124:127], a[216:219], v[92:107]
    s_waitcnt lgkmcnt(6)
    ds_read_b128 v[156:159], v246 offset:18432
    v_mul_f32 v197, v197, v77
    v_mul_f32 v198, v198, v78
    v_mul_f32 v199, v199, v79
    v_mul_f32 v200, v200, v84
    v_mul_f32 v201, v201, v85
    v_mfma_f32_32x32x16_bf16 v[92:107], v[128:131], a[220:223], v[92:107]
    s_waitcnt lgkmcnt(6)
    ds_read_b128 v[160:163], v246 offset:19456
    buffer_load_dwordx4 a[124:127], v249, s[32:35], s20 offen sc1
    v_mul_f32 v202, v202, v86
    v_mul_f32 v203, v203, v87
    v_mfma_f32_32x32x16_bf16 v[92:107], v[132:135], a[224:227], v[92:107]
    s_waitcnt lgkmcnt(6)
    ds_read_b128 v[124:127], v246 offset:20480
    v_exp_f32 v196, v196
    v_mul_f32 v76, v76, v80
    v_exp_f32 v197, v197
    v_mfma_f32_32x32x16_bf16 v[92:107], v[136:139], a[228:231], v[92:107]
    s_waitcnt lgkmcnt(6)
    ds_read_b128 v[128:131], v246 offset:21504
    v_mul_f32 v77, v77, v81
    v_exp_f32 v198, v198
    v_mul_f32 v78, v78, v82
    v_mfma_f32_32x32x16_bf16 v[92:107], v[140:143], a[232:235], v[92:107]
    s_waitcnt lgkmcnt(6)
    ds_read_b128 v[132:135], v246 offset:22528
    s_add_u32 s20, s6, 3072
    s_lshl_b32 s20, s20, 4
    buffer_load_dwordx4 a[128:131], v245, s[32:35], s20 offen sc1
    v_mfma_f32_32x32x16_bf16 v[92:107], v[144:147], a[236:239], v[92:107]
    s_waitcnt lgkmcnt(6)
    ds_read_b128 v[136:139], v246 offset:23552
    v_exp_f32 v199, v199
    v_mul_f32 v79, v79, v83
    v_exp_f32 v200, v200
    v_mfma_f32_32x32x16_bf16 v[92:107], v[148:151], a[240:243], v[92:107]
    s_waitcnt lgkmcnt(6)
    ds_read_b128 v[140:143], v246 offset:24576
    buffer_load_dwordx4 a[132:135], v249, s[32:35], s20 offen sc1
    v_mul_f32 v84, v84, v88
    v_exp_f32 v201, v201
    v_mfma_f32_32x32x16_bf16 v[92:107], v[152:155], a[244:247], v[92:107]
    s_waitcnt lgkmcnt(6)
    ds_read_b128 v[144:147], v246 offset:25600
    v_mul_f32 v85, v85, v89
    v_exp_f32 v202, v202
    v_mul_f32 v86, v86, v90
    v_mfma_f32_32x32x16_bf16 v[92:107], v[156:159], a[248:251], v[92:107]
    s_waitcnt lgkmcnt(6)
    ds_read_b128 v[148:151], v246 offset:26624
    v_exp_f32 v203, v203
    v_mul_f32 v87, v87, v91
    v_fma_f32 v196, v196, v231, v231
    v_fma_f32 v197, v197, v231, v231
    v_mfma_f32_32x32x16_bf16 v[92:107], v[160:163], a[252:255], v[92:107]
    s_waitcnt lgkmcnt(6)
    ds_read_b128 v[152:155], v246 offset:27648
    s_add_u32 s20, s6, 4096
    s_lshl_b32 s20, s20, 4
    buffer_load_dwordx4 a[136:139], v245, s[32:35], s20 offen sc1
    v_mfma_f32_32x32x16_bf16 v[92:107], v[124:127], v[28:31], v[92:107]
    s_waitcnt lgkmcnt(6)
    ds_read_b128 v[156:159], v246 offset:28672
    v_rcp_f32 v196, v196
    v_fma_f32 v198, v198, v231, v231
    v_rcp_f32 v197, v197
    v_mfma_f32_32x32x16_bf16 v[92:107], v[128:131], v[32:35], v[92:107]
    s_waitcnt lgkmcnt(6)
    ds_read_b128 v[160:163], v246 offset:29696
    buffer_load_dwordx4 a[140:143], v249, s[32:35], s20 offen sc1
    v_fma_f32 v199, v199, v231, v231
    v_rcp_f32 v198, v198
    v_mfma_f32_32x32x16_bf16 v[92:107], v[132:135], v[36:39], v[92:107]
    s_waitcnt lgkmcnt(6)
    ds_read_b128 v[124:127], v246 offset:30720
    v_fma_f32 v200, v200, v231, v231
    v_rcp_f32 v199, v199
    v_fma_f32 v201, v201, v231, v231
    v_mfma_f32_32x32x16_bf16 v[92:107], v[136:139], v[40:43], v[92:107]
    s_waitcnt lgkmcnt(6)
    ds_read_b128 v[128:131], v246 offset:31744
    v_rcp_f32 v200, v200
    v_fma_f32 v202, v202, v231, v231
    v_rcp_f32 v201, v201
    v_mfma_f32_32x32x16_bf16 v[92:107], v[140:143], v[44:47], v[92:107]
    s_waitcnt lgkmcnt(6)
    v_fma_f32 v203, v203, v231, v231
    v_rcp_f32 v202, v202
    v_rcp_f32 v203, v203
    v_mul_f32 v76, v76, v196
    v_mfma_f32_32x32x16_bf16 v[92:107], v[144:147], v[48:51], v[92:107]
    s_waitcnt lgkmcnt(5)
    v_mul_f32 v77, v77, v197
    v_mul_f32 v78, v78, v198
    v_mul_f32 v79, v79, v199
    v_mul_f32 v84, v84, v200
    v_mul_f32 v85, v85, v201
    v_mul_f32 v86, v86, v202
    v_mfma_f32_32x32x16_bf16 v[92:107], v[148:151], v[52:55], v[92:107]
    s_waitcnt lgkmcnt(4)
    v_mul_f32 v87, v87, v203
    v_cvt_pk_bf16_f32 v220, v76, v77
    v_cvt_pk_bf16_f32 v221, v78, v79
    v_cvt_pk_bf16_f32 v222, v84, v85
    v_cvt_pk_bf16_f32 v223, v86, v87
    v_mfma_f32_32x32x16_bf16 v[92:107], v[152:155], v[56:59], v[92:107]
    s_waitcnt lgkmcnt(3)
    buffer_store_dwordx4 v[220:223], v21, s[32:35], s17 offen offset:0 sc1
    v_mfma_f32_32x32x16_bf16 v[92:107], v[156:159], v[60:63], v[92:107]
    s_waitcnt lgkmcnt(2)
    v_mfma_f32_32x32x16_bf16 v[92:107], v[160:163], v[64:67], v[92:107]
    s_waitcnt lgkmcnt(1)
    v_mfma_f32_32x32x16_bf16 v[92:107], v[124:127], v[68:71], v[92:107]
    s_waitcnt lgkmcnt(0)
    v_mfma_f32_32x32x16_bf16 v[92:107], v[128:131], v[72:75], v[92:107]
    v_mfma_f32_32x32x16_bf16 v[92:107], v[6:9], v[204:207], v[92:107]
    buffer_load_dword v243, off, s[32:35], s85 sc1
    s_nop 10
    v_pk_mul_f32 v[196:197], v[92:93], v[92:93]
    v_pk_mul_f32 v[198:199], v[94:95], v[94:95]
    v_pk_mul_f32 v[200:201], v[100:101], v[100:101]
    v_pk_mul_f32 v[202:203], v[102:103], v[102:103]
    v_pk_fma_f32 v[196:197], v[196:197], v[230:231], v[228:229] op_sel:[0,0,1] op_sel_hi:[1,0,1]
    v_pk_fma_f32 v[198:199], v[198:199], v[230:231], v[228:229] op_sel:[0,0,1] op_sel_hi:[1,0,1]
    v_pk_fma_f32 v[200:201], v[200:201], v[230:231], v[228:229] op_sel:[0,0,1] op_sel_hi:[1,0,1]
    v_pk_fma_f32 v[202:203], v[202:203], v[230:231], v[228:229] op_sel:[0,0,1] op_sel_hi:[1,0,1]
    v_pk_mul_f32 v[196:197], v[196:197], v[92:93]
    v_pk_mul_f32 v[198:199], v[198:199], v[94:95]
    v_pk_mul_f32 v[200:201], v[200:201], v[100:101]
    v_pk_mul_f32 v[202:203], v[202:203], v[102:103]
    v_exp_f32 v196, v196
    v_exp_f32 v198, v198
    v_exp_f32 v200, v200
    v_exp_f32 v202, v202
    v_exp_f32 v197, v197
    v_exp_f32 v199, v199
    v_exp_f32 v201, v201
    v_exp_f32 v203, v203
    v_pk_mul_f32 v[92:93], v[92:93], v[96:97]
    v_pk_mul_f32 v[94:95], v[94:95], v[98:99]
    v_pk_mul_f32 v[100:101], v[100:101], v[104:105]
    v_pk_mul_f32 v[102:103], v[102:103], v[106:107]
    v_pk_fma_f32 v[196:197], v[196:197], v[230:231], v[230:231] op_sel:[0,1,1] op_sel_hi:[1,1,1]
    v_pk_fma_f32 v[198:199], v[198:199], v[230:231], v[230:231] op_sel:[0,1,1] op_sel_hi:[1,1,1]
    v_pk_fma_f32 v[200:201], v[200:201], v[230:231], v[230:231] op_sel:[0,1,1] op_sel_hi:[1,1,1]
    v_pk_fma_f32 v[202:203], v[202:203], v[230:231], v[230:231] op_sel:[0,1,1] op_sel_hi:[1,1,1]
    v_rcp_f32 v196, v196
    v_rcp_f32 v198, v198
    v_rcp_f32 v200, v200
    v_rcp_f32 v202, v202
    v_rcp_f32 v197, v197
    v_rcp_f32 v199, v199
    v_rcp_f32 v201, v201
    v_rcp_f32 v203, v203
    v_pk_mul_f32 v[92:93], v[92:93], v[196:197]
    v_pk_mul_f32 v[94:95], v[94:95], v[198:199]
    v_pk_mul_f32 v[100:101], v[100:101], v[200:201]
    v_pk_mul_f32 v[102:103], v[102:103], v[202:203]
    v_cvt_pk_bf16_f32 v224, v92, v93
    v_cvt_pk_bf16_f32 v225, v94, v95
    v_cvt_pk_bf16_f32 v226, v100, v101
    v_cvt_pk_bf16_f32 v227, v102, v103
    buffer_store_dwordx4 v[224:227], v21, s[32:35], s17 offen offset:1024 sc1
    s_branch L_join_32
L_five_31:
    buffer_load_dwordx4 a[108:111], v249, s[32:35], s20 offen sc1
    s_add_u32 s20, s5, 3072
    s_lshl_b32 s20, s20, 4
    buffer_load_dwordx4 a[112:115], v245, s[32:35], s20 offen sc1
    buffer_load_dwordx4 a[116:119], v249, s[32:35], s20 offen sc1
    s_add_u32 s20, s5, 4096
    s_lshl_b32 s20, s20, 4
    buffer_load_dwordx4 a[120:123], v245, s[32:35], s20 offen sc1
    buffer_load_dwordx4 a[124:127], v249, s[32:35], s20 offen sc1
    s_add_u32 s20, s6, 3072
    s_lshl_b32 s20, s20, 4
    buffer_load_dwordx4 a[128:131], v245, s[32:35], s20 offen sc1
    buffer_load_dwordx4 a[132:135], v249, s[32:35], s20 offen sc1
    s_add_u32 s20, s6, 4096
    s_lshl_b32 s20, s20, 4
    buffer_load_dwordx4 a[136:139], v245, s[32:35], s20 offen sc1
    buffer_load_dwordx4 a[140:143], v249, s[32:35], s20 offen sc1
    v_rcp_f32 v201, v201
    v_fma_f32 v203, v203, v231, v231
    v_rcp_f32 v202, v202
    v_rcp_f32 v203, v203
    v_mul_f32 v164, v164, v196
    v_mul_f32 v165, v165, v197
    v_mul_f32 v166, v166, v198
    v_mul_f32 v167, v167, v199
    v_mul_f32 v172, v172, v200
    v_mul_f32 v173, v173, v201
    v_mul_f32 v174, v174, v202
    v_mul_f32 v175, v175, v203
    v_cvt_pk_bf16_f32 v224, v164, v165
    v_cvt_pk_bf16_f32 v225, v166, v167
    v_cvt_pk_bf16_f32 v226, v172, v173
    v_cvt_pk_bf16_f32 v227, v174, v175
    buffer_store_dwordx4 v[224:227], v21, s[32:35], s16 offen offset:3072 sc1
    buffer_load_dword v243, off, s[32:35], s85 sc1
    v_pk_mul_f32 v[196:197], v[76:77], v[76:77]
    v_pk_mul_f32 v[198:199], v[78:79], v[78:79]
    v_pk_mul_f32 v[200:201], v[84:85], v[84:85]
    v_pk_mul_f32 v[202:203], v[86:87], v[86:87]
    v_pk_fma_f32 v[196:197], v[196:197], v[230:231], v[228:229] op_sel:[0,0,1] op_sel_hi:[1,0,1]
    v_pk_fma_f32 v[198:199], v[198:199], v[230:231], v[228:229] op_sel:[0,0,1] op_sel_hi:[1,0,1]
    v_pk_fma_f32 v[200:201], v[200:201], v[230:231], v[228:229] op_sel:[0,0,1] op_sel_hi:[1,0,1]
    v_pk_fma_f32 v[202:203], v[202:203], v[230:231], v[228:229] op_sel:[0,0,1] op_sel_hi:[1,0,1]
    v_pk_mul_f32 v[196:197], v[196:197], v[76:77]
    v_pk_mul_f32 v[198:199], v[198:199], v[78:79]
    v_pk_mul_f32 v[200:201], v[200:201], v[84:85]
    v_pk_mul_f32 v[202:203], v[202:203], v[86:87]
    v_exp_f32 v196, v196
    v_exp_f32 v198, v198
    v_exp_f32 v200, v200
    v_exp_f32 v202, v202
    v_exp_f32 v197, v197
    v_exp_f32 v199, v199
    v_exp_f32 v201, v201
    v_exp_f32 v203, v203
    v_pk_mul_f32 v[76:77], v[76:77], v[80:81]
    v_pk_mul_f32 v[78:79], v[78:79], v[82:83]
    v_pk_mul_f32 v[84:85], v[84:85], v[88:89]
    v_pk_mul_f32 v[86:87], v[86:87], v[90:91]
    v_pk_fma_f32 v[196:197], v[196:197], v[230:231], v[230:231] op_sel:[0,1,1] op_sel_hi:[1,1,1]
    v_pk_fma_f32 v[198:199], v[198:199], v[230:231], v[230:231] op_sel:[0,1,1] op_sel_hi:[1,1,1]
    v_pk_fma_f32 v[200:201], v[200:201], v[230:231], v[230:231] op_sel:[0,1,1] op_sel_hi:[1,1,1]
    v_pk_fma_f32 v[202:203], v[202:203], v[230:231], v[230:231] op_sel:[0,1,1] op_sel_hi:[1,1,1]
    v_rcp_f32 v196, v196
    v_rcp_f32 v198, v198
    v_rcp_f32 v200, v200
    v_rcp_f32 v202, v202
    v_rcp_f32 v197, v197
    v_rcp_f32 v199, v199
    v_rcp_f32 v201, v201
    v_rcp_f32 v203, v203
    v_pk_mul_f32 v[76:77], v[76:77], v[196:197]
    v_pk_mul_f32 v[78:79], v[78:79], v[198:199]
    v_pk_mul_f32 v[84:85], v[84:85], v[200:201]
    v_pk_mul_f32 v[86:87], v[86:87], v[202:203]
    v_cvt_pk_bf16_f32 v220, v76, v77
    v_cvt_pk_bf16_f32 v221, v78, v79
    v_cvt_pk_bf16_f32 v222, v84, v85
    v_cvt_pk_bf16_f32 v223, v86, v87
    buffer_store_dwordx4 v[220:223], v21, s[32:35], s17 offen offset:0 sc1
    s_waitcnt lgkmcnt(0)
L_join_32:
    s_add_u32 s20, s7, 3072
    s_lshl_b32 s20, s20, 4
    buffer_load_dwordx4 a[144:147], v245, s[32:35], s20 offen sc1
    buffer_load_dwordx4 a[148:151], v249, s[32:35], s20 offen sc1
    s_add_u32 s20, s7, 4096
    s_lshl_b32 s20, s20, 4
    buffer_load_dwordx4 a[152:155], v245, s[32:35], s20 offen sc1
    buffer_load_dwordx4 a[156:159], v249, s[32:35], s20 offen sc1
    s_add_u32 s20, s10, 5120
    s_lshl_b32 s20, s20, 4
    buffer_load_dwordx4 a[160:163], v245, s[32:35], s20 offen sc1
    buffer_load_dwordx4 a[164:167], v249, s[32:35], s20 offen sc1
    s_add_u32 s20, s11, 5120
    s_lshl_b32 s20, s20, 4
    buffer_load_dwordx4 a[168:171], v245, s[32:35], s20 offen sc1
    buffer_load_dwordx4 a[172:175], v249, s[32:35], s20 offen sc1
    s_lshl_b32 s72, s60, 12
    v_add_u32 v2, s72, v21
    v_add_u32 v3, 131072, v2
    v_xor_b32 v24, 4096, v2
    v_xor_b32 v25, 8192, v2
    v_xor_b32 v254, 12288, v3
    s_waitcnt vmcnt(8)
    s_barrier
    s_cmp_lg_u32 s60, 0
    s_cbranch_scc1 L_sk_33
    s_mov_b64 exec, 1
    buffer_atomic_add v23, v242, s[32:35], s84 offen offset:2048 sc1
    s_mov_b64 exec, -1
L_sk_33:
    s_cmp_lg_u32 s60, 1
    s_cbranch_scc1 L_sk_34
    v_readfirstlane_b32 s72, v243
    s_cmp_ge_u32 s72, 16
    s_cbranch_scc1 L_sk_35
    s_mov_b64 exec, 1
    s_mov_b32 s82, 0
L_poll_36:
    buffer_load_dword v243, v242, s[32:35], s85 offen sc1
    s_add_u32 s82, s82, 1
    s_cmp_gt_u32 s82, 0x40000
    s_cbranch_scc1 L_end
    s_waitcnt vmcnt(0)
    v_cmp_gt_u32 vcc, 16, v243
    s_cbranch_vccz L_pok_37
    s_sleep 1
    s_branch L_poll_36
L_pok_37:
    s_mov_b64 exec, -1
L_sk_35:
L_sk_34:
    s_barrier
    s_add_u32 s20, s4, 0
    buffer_load_dwordx4 a[180:183], v253, s[32:35], s20 offen sc1
    s_add_u32 s20, s4, 1024
    buffer_load_dwordx4 a[188:191], v253, s[32:35], s20 offen sc1
    s_add_u32 s20, s4, 2048
    buffer_load_dwordx4 a[196:199], v253, s[32:35], s20 offen sc1
    s_add_u32 s20, s5, 0
    buffer_load_dwordx4 a[204:207], v253, s[32:35], s20 offen sc1
    s_add_u32 s20, s5, 1024
    buffer_load_dwordx4 a[212:215], v253, s[32:35], s20 offen sc1
    s_add_u32 s20, s5, 2048
    buffer_load_dwordx4 a[220:223], v253, s[32:35], s20 offen sc1
    s_waitcnt vmcnt(5)
    v_mfma_f32_32x32x16_bf16 v[172:187], a[4:7], a[180:183], 0
    s_add_u32 s20, s6, 0
    buffer_load_dwordx4 a[228:231], v253, s[32:35], s20 offen sc1
    v_mfma_f32_32x32x16_bf16 v[140:155], a[0:3], a[180:183], 0
    s_waitcnt vmcnt(5)
    s_add_u32 s20, s6, 1024
    buffer_load_dwordx4 a[236:239], v253, s[32:35], s20 offen sc1
    v_mfma_f32_32x32x16_bf16 v[172:187], a[12:15], a[188:191], v[172:187]
    s_add_u32 s20, s6, 2048
    buffer_load_dwordx4 a[244:247], v253, s[32:35], s20 offen sc1
    v_mfma_f32_32x32x16_bf16 v[140:155], a[8:11], a[188:191], v[140:155]
    s_waitcnt vmcnt(6)
    s_add_u32 s20, s7, 0
    buffer_load_dwordx4 a[252:255], v253, s[32:35], s20 offen sc1
    v_mfma_f32_32x32x16_bf16 v[172:187], a[20:23], a[196:199], v[172:187]
    s_add_u32 s20, s7, 1024
    buffer_load_dwordx4 v[32:35], v253, s[32:35], s20 offen sc1
    v_mfma_f32_32x32x16_bf16 v[140:155], a[16:19], a[196:199], v[140:155]
    s_waitcnt vmcnt(7)
    s_add_u32 s20, s7, 2048
    buffer_load_dwordx4 v[40:43], v253, s[32:35], s20 offen sc1
    v_mfma_f32_32x32x16_bf16 v[172:187], a[28:31], a[204:207], v[172:187]
    s_add_u32 s20, s4, 0
    buffer_load_dwordx4 a[176:179], v250, s[32:35], s20 offen sc1
    v_mfma_f32_32x32x16_bf16 v[140:155], a[24:27], a[204:207], v[140:155]
    s_waitcnt vmcnt(8)
    s_add_u32 s20, s4, 1024
    buffer_load_dwordx4 a[184:187], v250, s[32:35], s20 offen sc1
    v_mfma_f32_32x32x16_bf16 v[172:187], a[36:39], a[212:215], v[172:187]
    s_add_u32 s20, s4, 2048
    buffer_load_dwordx4 a[192:195], v250, s[32:35], s20 offen sc1
    v_mfma_f32_32x32x16_bf16 v[140:155], a[32:35], a[212:215], v[140:155]
    s_waitcnt vmcnt(9)
    s_add_u32 s20, s5, 0
    buffer_load_dwordx4 a[200:203], v250, s[32:35], s20 offen sc1
    v_mfma_f32_32x32x16_bf16 v[172:187], a[44:47], a[220:223], v[172:187]
    s_add_u32 s20, s5, 1024
    buffer_load_dwordx4 a[208:211], v250, s[32:35], s20 offen sc1
    v_mfma_f32_32x32x16_bf16 v[140:155], a[40:43], a[220:223], v[140:155]
    s_waitcnt vmcnt(10)
    s_add_u32 s20, s5, 2048
    buffer_load_dwordx4 a[216:219], v250, s[32:35], s20 offen sc1
    v_mfma_f32_32x32x16_bf16 v[172:187], a[52:55], a[228:231], v[172:187]
    v_mfma_f32_32x32x16_bf16 v[140:155], a[48:51], a[228:231], v[140:155]
    s_waitcnt vmcnt(10)
    v_mfma_f32_32x32x16_bf16 v[172:187], a[60:63], a[236:239], v[172:187]
    v_mfma_f32_32x32x16_bf16 v[140:155], a[56:59], a[236:239], v[140:155]
    s_waitcnt vmcnt(9)
    v_mfma_f32_32x32x16_bf16 v[172:187], a[68:71], a[244:247], v[172:187]
    buffer_load_dword v243, off, s[32:35], s87 sc1
    v_mfma_f32_32x32x16_bf16 v[140:155], a[64:67], a[244:247], v[140:155]
    s_waitcnt vmcnt(9)
    v_mfma_f32_32x32x16_bf16 v[172:187], a[76:79], a[252:255], v[172:187]
    v_mfma_f32_32x32x16_bf16 v[140:155], a[72:75], a[252:255], v[140:155]
    s_waitcnt vmcnt(8)
    v_mfma_f32_32x32x16_bf16 v[172:187], a[84:87], v[32:35], v[172:187]
    v_mfma_f32_32x32x16_bf16 v[140:155], a[80:83], v[32:35], v[140:155]
    s_waitcnt vmcnt(7)
    v_mfma_f32_32x32x16_bf16 v[172:187], a[92:95], v[40:43], v[172:187]
    v_mfma_f32_32x32x16_bf16 v[140:155], a[88:91], v[40:43], v[140:155]
    s_waitcnt vmcnt(6)
    v_mfma_f32_32x32x16_bf16 v[156:171], a[4:7], a[176:179], 0
    v_mfma_f32_32x32x16_bf16 v[124:139], a[0:3], a[176:179], 0
    s_waitcnt vmcnt(5)
    v_mfma_f32_32x32x16_bf16 v[156:171], a[12:15], a[184:187], v[156:171]
    s_cmp_lg_u32 s60, 1
    s_cbranch_scc1 L_sk_38
    s_waitcnt vmcnt(0)
    v_readfirstlane_b32 s72, v243
    s_cmp_ge_u32 s72, 16
    s_cbranch_scc1 L_sk_39
    s_mov_b64 exec, 1
    s_mov_b32 s82, 0
L_poll_40:
    buffer_load_dword v243, v242, s[32:35], s87 offen sc1
    s_add_u32 s82, s82, 1
    s_cmp_gt_u32 s82, 0x40000
    s_cbranch_scc1 L_end
    s_waitcnt vmcnt(0)
    v_cmp_gt_u32 vcc, 16, v243
    s_cbranch_vccz L_pok_41
    s_sleep 1
    s_branch L_poll_40
L_pok_41:
    s_mov_b64 exec, -1
L_sk_39:
L_sk_38:
    s_barrier
    s_add_u32 s20, s11, 5120
    buffer_load_dwordx4 v[120:123], v253, s[32:35], s20 offen sc1
    s_add_u32 s20, s4, 3072
    buffer_load_dwordx4 v[48:51], v253, s[32:35], s20 offen sc1
    s_add_u32 s20, s4, 4096
    buffer_load_dwordx4 v[56:59], v253, s[32:35], s20 offen sc1
    s_add_u32 s20, s5, 3072
    buffer_load_dwordx4 v[64:67], v253, s[32:35], s20 offen sc1
    v_mfma_f32_32x32x16_bf16 v[124:139], a[8:11], a[184:187], v[124:139]
    s_waitcnt vmcnt(7)
    s_add_u32 s20, s5, 4096
    buffer_load_dwordx4 v[72:75], v253, s[32:35], s20 offen sc1
    v_mfma_f32_32x32x16_bf16 v[156:171], a[20:23], a[192:195], v[156:171]
    s_add_u32 s20, s6, 3072
    buffer_load_dwordx4 v[80:83], v253, s[32:35], s20 offen sc1
    v_mfma_f32_32x32x16_bf16 v[124:139], a[16:19], a[192:195], v[124:139]
    s_waitcnt vmcnt(8)
    s_add_u32 s20, s6, 4096
    buffer_load_dwordx4 v[88:91], v253, s[32:35], s20 offen sc1
    v_mfma_f32_32x32x16_bf16 v[156:171], a[28:31], a[200:203], v[156:171]
    s_add_u32 s20, s7, 3072
    buffer_load_dwordx4 v[96:99], v253, s[32:35], s20 offen sc1
    v_mfma_f32_32x32x16_bf16 v[124:139], a[24:27], a[200:203], v[124:139]
    s_waitcnt vmcnt(9)
    s_add_u32 s20, s7, 4096
    buffer_load_dwordx4 v[104:107], v253, s[32:35], s20 offen sc1
    v_mfma_f32_32x32x16_bf16 v[156:171], a[36:39], a[208:211], v[156:171]
    s_add_u32 s20, s10, 5120
    buffer_load_dwordx4 v[112:115], v253, s[32:35], s20 offen sc1
    v_mfma_f32_32x32x16_bf16 v[124:139], a[32:35], a[208:211], v[124:139]
    s_waitcnt vmcnt(10)
    s_add_u32 s20, s6, 0
    buffer_load_dwordx4 a[224:227], v250, s[32:35], s20 offen sc1
    v_mfma_f32_32x32x16_bf16 v[156:171], a[44:47], a[216:219], v[156:171]
    s_add_u32 s20, s6, 1024
    buffer_load_dwordx4 a[232:235], v250, s[32:35], s20 offen sc1
    v_mfma_f32_32x32x16_bf16 v[124:139], a[40:43], a[216:219], v[124:139]
    s_waitcnt vmcnt(11)
    s_add_u32 s20, s6, 2048
    buffer_load_dwordx4 a[240:243], v250, s[32:35], s20 offen sc1
    s_cmp_ge_u32 s60, 2
    s_cbranch_scc1 L_sk_42
    v_mfma_f32_32x32x16_bf16 v[172:187], a[172:175], v[120:123], v[172:187]
    v_mfma_f32_32x32x16_bf16 v[140:155], a[168:171], v[120:123], v[140:155]
L_sk_42:
    s_waitcnt vmcnt(11)
    s_add_u32 s20, s7, 0
    buffer_load_dwordx4 a[248:251], v250, s[32:35], s20 offen sc1
    v_mfma_f32_32x32x16_bf16 v[172:187], a[100:103], v[48:51], v[172:187]
    s_add_u32 s20, s7, 1024
    buffer_load_dwordx4 v[28:31], v250, s[32:35], s20 offen sc1
    v_mfma_f32_32x32x16_bf16 v[140:155], a[96:99], v[48:51], v[140:155]
    s_waitcnt vmcnt(12)
    s_add_u32 s20, s7, 2048
    buffer_load_dwordx4 v[36:39], v250, s[32:35], s20 offen sc1
    v_mfma_f32_32x32x16_bf16 v[172:187], a[108:111], v[56:59], v[172:187]
    s_add_u32 s20, s11, 5120
    buffer_load_dwordx4 v[116:119], v250, s[32:35], s20 offen sc1
    v_mfma_f32_32x32x16_bf16 v[140:155], a[104:107], v[56:59], v[140:155]
    s_waitcnt vmcnt(13)
    s_add_u32 s20, s4, 3072
    buffer_load_dwordx4 v[44:47], v250, s[32:35], s20 offen sc1
    v_mfma_f32_32x32x16_bf16 v[172:187], a[116:119], v[64:67], v[172:187]
    s_add_u32 s20, s4, 4096
    buffer_load_dwordx4 v[52:55], v250, s[32:35], s20 offen sc1
    v_mfma_f32_32x32x16_bf16 v[140:155], a[112:115], v[64:67], v[140:155]
    s_waitcnt vmcnt(14)
    s_add_u32 s20, s5, 3072
    buffer_load_dwordx4 v[60:63], v250, s[32:35], s20 offen sc1
    v_mfma_f32_32x32x16_bf16 v[172:187], a[124:127], v[72:75], v[172:187]
    s_add_u32 s20, s5, 4096
    buffer_load_dwordx4 v[68:71], v250, s[32:35], s20 offen sc1
    v_mfma_f32_32x32x16_bf16 v[140:155], a[120:123], v[72:75], v[140:155]
    s_waitcnt vmcnt(15)
    s_add_u32 s20, s6, 3072
    buffer_load_dwordx4 v[76:79], v250, s[32:35], s20 offen sc1
    v_mfma_f32_32x32x16_bf16 v[172:187], a[132:135], v[80:83], v[172:187]
    s_add_u32 s20, s6, 4096
    buffer_load_dwordx4 v[84:87], v250, s[32:35], s20 offen sc1
    v_mfma_f32_32x32x16_bf16 v[140:155], a[128:131], v[80:83], v[140:155]
    s_waitcnt vmcnt(16)
    s_add_u32 s20, s7, 3072
    buffer_load_dwordx4 v[92:95], v250, s[32:35], s20 offen sc1
    v_mfma_f32_32x32x16_bf16 v[172:187], a[140:143], v[88:91], v[172:187]
    s_add_u32 s20, s7, 4096
    buffer_load_dwordx4 v[100:103], v250, s[32:35], s20 offen sc1
    v_mfma_f32_32x32x16_bf16 v[140:155], a[136:139], v[88:91], v[140:155]
    s_waitcnt vmcnt(17)
    s_add_u32 s20, s10, 5120
    buffer_load_dwordx4 v[108:111], v250, s[32:35], s20 offen sc1
    v_mfma_f32_32x32x16_bf16 v[172:187], a[148:151], v[96:99], v[172:187]
    v_mfma_f32_32x32x16_bf16 v[140:155], a[144:147], v[96:99], v[140:155]
    s_waitcnt vmcnt(17)
    v_mfma_f32_32x32x16_bf16 v[172:187], a[156:159], v[104:107], v[172:187]
    v_mfma_f32_32x32x16_bf16 v[140:155], a[152:155], v[104:107], v[140:155]
    s_waitcnt vmcnt(16)
    v_mfma_f32_32x32x16_bf16 v[172:187], a[164:167], v[112:115], v[172:187]
    v_mfma_f32_32x32x16_bf16 v[140:155], a[160:163], v[112:115], v[140:155]
    s_waitcnt vmcnt(15)
    v_mfma_f32_32x32x16_bf16 v[156:171], a[52:55], a[224:227], v[156:171]
    v_mfma_f32_32x32x16_bf16 v[124:139], a[48:51], a[224:227], v[124:139]
    s_waitcnt vmcnt(14)
    v_mfma_f32_32x32x16_bf16 v[156:171], a[60:63], a[232:235], v[156:171]
    v_mfma_f32_32x32x16_bf16 v[124:139], a[56:59], a[232:235], v[124:139]
    s_waitcnt vmcnt(13)
    s_nop 3
    ds_write_b128 v3, v[172:175] offset:0
    v_mfma_f32_32x32x16_bf16 v[156:171], a[68:71], a[240:243], v[156:171]
    ds_write_b128 v3, v[176:179] offset:1024
    v_mfma_f32_32x32x16_bf16 v[124:139], a[64:67], a[240:243], v[124:139]
    s_waitcnt vmcnt(12)
    ds_write_b128 v3, v[180:183] offset:2048
    v_mfma_f32_32x32x16_bf16 v[156:171], a[76:79], a[248:251], v[156:171]
    ds_write_b128 v3, v[184:187] offset:3072
    v_mfma_f32_32x32x16_bf16 v[124:139], a[72:75], a[248:251], v[124:139]
    s_waitcnt vmcnt(11)
    ds_write_b128 v2, v[140:143] offset:0
    v_mfma_f32_32x32x16_bf16 v[156:171], a[84:87], v[28:31], v[156:171]
    ds_write_b128 v2, v[144:147] offset:1024
    v_mfma_f32_32x32x16_bf16 v[124:139], a[80:83], v[28:31], v[124:139]
    s_waitcnt vmcnt(10)
    ds_write_b128 v2, v[148:151] offset:2048
    v_mfma_f32_32x32x16_bf16 v[156:171], a[92:95], v[36:39], v[156:171]
    ds_write_b128 v2, v[152:155] offset:3072
    v_mfma_f32_32x32x16_bf16 v[124:139], a[88:91], v[36:39], v[124:139]
    s_waitcnt vmcnt(9)
    s_cmp_ge_u32 s60, 2
    s_cbranch_scc1 L_sk_43
    v_mfma_f32_32x32x16_bf16 v[156:171], a[172:175], v[116:119], v[156:171]
    v_mfma_f32_32x32x16_bf16 v[124:139], a[168:171], v[116:119], v[124:139]
L_sk_43:
    s_waitcnt vmcnt(8)
    v_mfma_f32_32x32x16_bf16 v[156:171], a[100:103], v[44:47], v[156:171]
    v_mfma_f32_32x32x16_bf16 v[124:139], a[96:99], v[44:47], v[124:139]
    s_waitcnt lgkmcnt(0)
    s_barrier
    s_waitcnt vmcnt(7)
    v_mfma_f32_32x32x16_bf16 v[156:171], a[108:111], v[52:55], v[156:171]
    ds_read_b128 v[172:175], v254 offset:0
    v_mfma_f32_32x32x16_bf16 v[124:139], a[104:107], v[52:55], v[124:139]
    s_waitcnt vmcnt(6)
    ds_read_b128 v[176:179], v254 offset:1024
    v_mfma_f32_32x32x16_bf16 v[156:171], a[116:119], v[60:63], v[156:171]
    ds_read_b128 v[180:183], v254 offset:2048
    v_mfma_f32_32x32x16_bf16 v[124:139], a[112:115], v[60:63], v[124:139]
    s_waitcnt vmcnt(5)
    ds_read_b128 v[184:187], v254 offset:3072
    v_mfma_f32_32x32x16_bf16 v[156:171], a[124:127], v[68:71], v[156:171]
    ds_read_b128 v[140:143], v24 offset:0
    v_mfma_f32_32x32x16_bf16 v[124:139], a[120:123], v[68:71], v[124:139]
    s_waitcnt vmcnt(4)
    ds_read_b128 v[144:147], v24 offset:1024
    v_mfma_f32_32x32x16_bf16 v[156:171], a[132:135], v[76:79], v[156:171]
    ds_read_b128 v[148:151], v24 offset:2048
    v_mfma_f32_32x32x16_bf16 v[124:139], a[128:131], v[76:79], v[124:139]
    s_waitcnt vmcnt(3)
    ds_read_b128 v[152:155], v24 offset:3072
    v_mfma_f32_32x32x16_bf16 v[156:171], a[140:143], v[84:87], v[156:171]
    s_waitcnt lgkmcnt(0)
    v_add_f32 v140, v140, v172
    v_add_f32 v141, v141, v173
    v_add_f32 v142, v142, v174
    v_add_f32 v143, v143, v175
    v_add_f32 v144, v144, v176
    v_add_f32 v145, v145, v177
    v_mfma_f32_32x32x16_bf16 v[124:139], a[136:139], v[84:87], v[124:139]
    s_waitcnt vmcnt(2)
    v_add_f32 v146, v146, v178
    v_add_f32 v147, v147, v179
    v_add_f32 v148, v148, v180
    v_add_f32 v149, v149, v181
    v_add_f32 v150, v150, v182
    v_add_f32 v151, v151, v183
    v_mfma_f32_32x32x16_bf16 v[156:171], a[148:151], v[92:95], v[156:171]
    v_add_f32 v152, v152, v184
    v_add_f32 v153, v153, v185
    v_add_f32 v154, v154, v186
    v_add_f32 v155, v155, v187
    v_lshlrev_b32 v172, 16, v232
    v_and_b32 v173, 0xffff0000, v232
    v_mfma_f32_32x32x16_bf16 v[124:139], a[144:147], v[92:95], v[124:139]
    s_waitcnt vmcnt(1)
    v_lshlrev_b32 v174, 16, v233
    v_and_b32 v175, 0xffff0000, v233
    v_lshlrev_b32 v176, 16, v234
    v_and_b32 v177, 0xffff0000, v234
    v_lshlrev_b32 v178, 16, v235
    v_and_b32 v179, 0xffff0000, v235
    v_mfma_f32_32x32x16_bf16 v[156:171], a[156:159], v[100:103], v[156:171]
    v_lshlrev_b32 v180, 16, v236
    v_and_b32 v181, 0xffff0000, v236
    v_lshlrev_b32 v182, 16, v237
    v_and_b32 v183, 0xffff0000, v237
    v_lshlrev_b32 v184, 16, v238
    v_and_b32 v185, 0xffff0000, v238
    v_mfma_f32_32x32x16_bf16 v[124:139], a[152:155], v[100:103], v[124:139]
    s_waitcnt vmcnt(0)
    v_lshlrev_b32 v186, 16, v239
    v_and_b32 v187, 0xffff0000, v239
    v_add_f32 v140, v140, v172
    v_add_f32 v141, v141, v173
    v_add_f32 v142, v142, v174
    v_add_f32 v143, v143, v175
    v_mfma_f32_32x32x16_bf16 v[156:171], a[164:167], v[108:111], v[156:171]
    v_add_f32 v144, v144, v176
    v_add_f32 v145, v145, v177
    v_add_f32 v146, v146, v178
    v_add_f32 v147, v147, v179
    v_add_f32 v148, v148, v180
    v_add_f32 v149, v149, v181
    v_mfma_f32_32x32x16_bf16 v[124:139], a[160:163], v[108:111], v[124:139]
    v_add_f32 v150, v150, v182
    v_add_f32 v151, v151, v183
    v_add_f32 v152, v152, v184
    v_add_f32 v153, v153, v185
    v_add_f32 v154, v154, v186
    v_add_f32 v155, v155, v187
    ds_write_b128 v2, v[156:159] offset:16384
    ds_write_b128 v2, v[160:163] offset:17408
    ds_write_b128 v2, v[164:167] offset:18432
    ds_write_b128 v2, v[168:171] offset:19456
    s_nop 1
    v_pk_add_f32 v[124:125], v[124:125], v[140:141]
    v_pk_add_f32 v[126:127], v[126:127], v[142:143]
    v_pk_add_f32 v[128:129], v[128:129], v[144:145]
    v_pk_add_f32 v[130:131], v[130:131], v[146:147]
    v_pk_add_f32 v[132:133], v[132:133], v[148:149]
    v_pk_add_f32 v[134:135], v[134:135], v[150:151]
    v_pk_add_f32 v[136:137], v[136:137], v[152:153]
    v_pk_add_f32 v[138:139], v[138:139], v[154:155]
    s_waitcnt lgkmcnt(0)
    s_barrier
    ds_read_b128 v[156:159], v25 offset:16384
    ds_read_b128 v[160:163], v25 offset:17408
    ds_read_b128 v[164:167], v25 offset:18432
    ds_read_b128 v[168:171], v25 offset:19456
    s_waitcnt lgkmcnt(3)
    v_pk_add_f32 v[124:125], v[124:125], v[156:157]
    v_pk_add_f32 v[126:127], v[126:127], v[158:159]
    v_cvt_pk_bf16_f32 v232, v124, v125
    v_cvt_pk_bf16_f32 v233, v126, v127
    s_waitcnt lgkmcnt(2)
    v_pk_add_f32 v[128:129], v[128:129], v[160:161]
    v_pk_add_f32 v[130:131], v[130:131], v[162:163]
    v_cvt_pk_bf16_f32 v234, v128, v129
    v_cvt_pk_bf16_f32 v235, v130, v131
    s_waitcnt lgkmcnt(1)
    v_pk_add_f32 v[132:133], v[132:133], v[164:165]
    v_pk_add_f32 v[134:135], v[134:135], v[166:167]
    v_cvt_pk_bf16_f32 v236, v132, v133
    v_cvt_pk_bf16_f32 v237, v134, v135
    s_waitcnt lgkmcnt(0)
    v_pk_add_f32 v[136:137], v[136:137], v[168:169]
    v_pk_add_f32 v[138:139], v[138:139], v[170:171]
    v_cvt_pk_bf16_f32 v238, v136, v137
    v_cvt_pk_bf16_f32 v239, v138, v139
    buffer_store_dwordx4 v[232:235], v240, s[52:55], s83 offen
    buffer_store_dwordx4 v[236:239], v240, s[52:55], s83 offen offset:16
L_end:
    s_endpgm
.section .rodata,"a"
.p2align 6
.amdhsa_kernel sequential_preLN__linear_attn_block__geglu_ffn__prompt_kernel
  .amdhsa_next_free_vgpr 512
  .amdhsa_next_free_sgpr 102
  .amdhsa_accum_offset 256
  .amdhsa_group_segment_fixed_size 0
  .amdhsa_kernarg_size 80
  .amdhsa_user_sgpr_count 2
  .amdhsa_user_sgpr_kernarg_segment_ptr 1
  .amdhsa_system_sgpr_workgroup_id_x 1
.end_amdhsa_kernel
```
